```python
import torch

def _softmax(x, axis=-1):
    return torch.softmax(x, dim=axis)
def _gelu(x):
    return torch.nn.functional.gelu(x, approximate="tanh")
def _silu(x):
    return torch.nn.functional.silu(x)
def _sigmoid(x):
    return torch.sigmoid(x)
def _layernorm(x, axis=-1, eps=1e-5):
    m = x.mean(dim=axis, keepdim=True)
    v = x.var(dim=axis, keepdim=True, unbiased=False)
    return (x - m) / torch.sqrt(v + eps)
def _scatter_add(tgt, idx, src, axis=0):
    return tgt.clone().index_add_(axis, idx, src)
def _segment_sum(src, seg, n):
    out = torch.zeros((n,) + src.shape[1:], dtype=src.dtype)
    return out.index_add_(0, seg, src)
def _pad(x, pw):
    flat = tuple(v for pair in reversed(pw) for v in pair)
    return torch.nn.functional.pad(x, flat)

kernel_name = 'standalone__mha_softmax__near_ridge'

def setup_inputs():

    _w = (lambda a: (lambda t: t.to(torch.bfloat16) if t.is_floating_point() else t)(torch.as_tensor(a)))
    B, H, Sq, Sk, D = 8, 16, 624, 1024, 256
    return {
        "q": _w((lambda *s: torch.randn(*s, dtype=torch.bfloat16) * 0.8)(B, H, Sq, D)),
        "k": _w((lambda *s: torch.randn(*s, dtype=torch.bfloat16) * 0.8)(B, H, Sk, D)),
        "v": _w((lambda *s: torch.randn(*s, dtype=torch.bfloat16) * 0.05)(B, H, Sk, D)),
    }

def reference(q, k, v):
    scale = q.shape[-1] ** -0.5
    scores = torch.einsum("bhqd,bhkd->bhqk", q, k) * scale
    p = _softmax(scores, axis=-1)
    return torch.einsum("bhqk,bhkd->bhqd", p, v)
```

```asm
; @launch grid=(256,1,1) block=(256,1,1) lds=163840
.amdgcn_target "amdgcn-amd-amdhsa--gfx950"
.text
.globl standalone__mha_softmax__near_ridge_kernel
.p2align 8
.type standalone__mha_softmax__near_ridge_kernel,@function
standalone__mha_softmax__near_ridge_kernel:
    s_cmp_ge_u32 s2, 256
    s_cbranch_scc1 L_end
    s_load_dwordx4 s[44:47], s[0:1], 0
    s_load_dwordx4 s[48:51], s[0:1], 16
    v_lshrrev_b32 v212, 6, v0
    v_and_b32 v255, 63, v0
    v_readfirstlane_b32 s29, v212
    s_getpc_b64 s[96:97]
L_pc:
    s_sub_u32 s96, s96, L_pc-standalone__mha_softmax__near_ridge_kernel
    s_subb_u32 s97, s97, 0
    s_and_b32 s97, s97, 0xffff
    s_mov_b32 s98, L_codeend-standalone__mha_softmax__near_ridge_kernel
    s_mov_b32 s99, 0x00020000
    s_mov_b32 s100, L_endphase-standalone__mha_softmax__near_ridge_kernel
    v_lshlrev_b32 v236, 7, v0
    s_mov_b32 s30, 32768
    buffer_load_dword v237, v236, s[96:99], 0 offen offset:0
    buffer_load_dword v237, v236, s[96:99], s30 offen offset:0
    s_and_b32 s30, s2, 7
    s_lshr_b32 s31, s2, 4
    s_lshl_b32 s31, s31, 3
    s_add_u32 s30, s30, s31
    s_lshr_b32 s31, s2, 3
    s_and_b32 s31, s31, 1
    s_mul_i32 s31, s31, 320
    s_mul_i32 s32, s29, 80
    s_add_u32 s40, s31, s32
    s_cmp_ge_u32 s40, 560
    s_mov_b32 s101, 0x7f800000
    s_cselect_b32 s101, 0xf149f2ca, s101
    s_mul_i32 s41, s30, 319488
    s_lshl_b32 s59, s30, 19
    s_lshl_b32 s30, s29, 12
    s_add_u32 s22, s30, 0
    s_add_u32 s23, s30, 16384
    s_add_u32 s24, s30, 65536
    s_add_u32 s25, s30, 49152
    s_add_u32 s35, s30, 32768
    s_mul_i32 s34, s29, 20480
    s_add_u32 s34, s34, 81920
    s_mov_b32 s26, 0x3db8aa3b
    s_mov_b32 s28, 0
    s_mov_b64 s[42:43], 0
    s_mov_b32 s54, 0
    s_mov_b32 s55, 8192
    s_mov_b32 s56, 16384
    s_mov_b32 s57, 24576
    s_mov_b32 s58, 32768
    s_and_b32 s30, s29, 1
    s_lshr_b32 s31, s29, 1
    s_lshl_b32 s32, s30, 13
    s_lshl_b32 s33, s31, 8
    s_add_u32 s32, s32, s33
    s_lshl_b32 s30, s30, 1
    v_and_b32 v212, 3, v255
    v_xor_b32 v212, s30, v212
    v_lshlrev_b32 v212, 4, v212
    v_lshrrev_b32 v213, 4, v255
    v_lshl_add_u32 v212, v213, 6, v212
    v_bfe_u32 v213, v255, 2, 1
    v_lshl_add_u32 v212, v213, 9, v212
    v_bfe_u32 v213, v255, 3, 1
    v_lshl_add_u32 v212, v213, 12, v212
    v_add_u32 v254, s32, v212
    s_waitcnt lgkmcnt(0)
    s_add_u32 s8, s46, s59
    s_addc_u32 s9, s47, 0
    s_and_b32 s9, s9, 0xffff
    s_mov_b32 s10, 524288
    s_mov_b32 s11, 0x00020000
    s_add_u32 s4, s44, s41
    s_addc_u32 s5, s45, 0
    s_and_b32 s5, s5, 0xffff
    s_mov_b32 s6, 319488
    s_mov_b32 s7, 0x00020000
    s_add_u32 s12, s48, s59
    s_addc_u32 s13, s49, 0
    s_and_b32 s13, s13, 0xffff
    s_mov_b32 s14, 524288
    s_mov_b32 s15, 0x00020000
    s_add_u32 s16, s50, s41
    s_addc_u32 s17, s51, 0
    s_and_b32 s17, s17, 0xffff
    s_mov_b32 s18, 319488
    s_mov_b32 s19, 0x00020000
    s_cmp_lt_u32 s29, 2
    s_cselect_b32 s92, s8, s12
    s_cselect_b32 s93, s9, s13
    s_mov_b32 s94, 524288
    s_mov_b32 s95, 0x00020000
L_restart:
    s_mov_b32 m0, s22
    s_mov_b32 s30, 0
    buffer_load_dwordx4 v254, s[8:11], s30 offen offset:0 nt lds
    s_mov_b32 m0, s22
    s_mov_b32 s30, 0
    buffer_load_dwordx4 v254, s[8:11], s30 offen offset:1024 nt lds
    s_mov_b32 m0, s22
    s_mov_b32 s30, 0
    buffer_load_dwordx4 v254, s[8:11], s30 offen offset:2048 nt lds
    s_mov_b32 m0, s22
    s_mov_b32 s30, 0
    buffer_load_dwordx4 v254, s[8:11], s30 offen offset:3072 nt lds
    v_and_b32 v212, 7, v255
    v_add_u32 v212, s40, v212
    v_lshlrev_b32 v212, 9, v212
    v_bfe_u32 v213, v255, 3, 1
    v_lshl_add_u32 v212, v213, 6, v212
    v_lshrrev_b32 v213, 4, v255
    v_lshl_add_u32 v236, v213, 4, v212
    buffer_load_dwordx4 v[64:67], v236, s[4:7], s54 offen offset:0 nt
    s_add_u32 s31, s54, 4096
    buffer_load_dwordx4 v[68:71], v236, s[4:7], s31 offen offset:0 nt
    buffer_load_dwordx4 v[72:75], v236, s[4:7], s54 offen offset:128 nt
    s_add_u32 s31, s54, 4096
    buffer_load_dwordx4 v[76:79], v236, s[4:7], s31 offen offset:128 nt
    buffer_load_dwordx4 v[80:83], v236, s[4:7], s54 offen offset:256 nt
    s_add_u32 s31, s54, 4096
    buffer_load_dwordx4 v[84:87], v236, s[4:7], s31 offen offset:256 nt
    buffer_load_dwordx4 v[88:91], v236, s[4:7], s54 offen offset:384 nt
    s_add_u32 s31, s54, 4096
    buffer_load_dwordx4 v[92:95], v236, s[4:7], s31 offen offset:384 nt
    v_bfe_u32 v212, v255, 2, 2
    v_add_u32 v212, s40, v212
    v_lshlrev_b32 v212, 9, v212
    v_lshrrev_b32 v213, 4, v255
    v_lshl_add_u32 v212, v213, 6, v212
    v_and_b32 v213, 3, v255
    v_lshl_add_u32 v238, v213, 4, v212
    v_xor_b32 v239, 32, v238
    s_mov_b32 m0, s23
    s_mov_b32 s30, 16384
    buffer_load_dwordx4 v254, s[8:11], s30 offen offset:0 nt lds
    s_mov_b32 m0, s23
    s_mov_b32 s30, 16384
    buffer_load_dwordx4 v254, s[8:11], s30 offen offset:1024 nt lds
    s_mov_b32 m0, s23
    s_mov_b32 s30, 16384
    buffer_load_dwordx4 v254, s[8:11], s30 offen offset:2048 nt lds
    s_mov_b32 m0, s23
    s_mov_b32 s30, 16384
    buffer_load_dwordx4 v254, s[8:11], s30 offen offset:3072 nt lds
    v_bfe_u32 v212, v255, 2, 1
    v_lshrrev_b32 v213, 4, v255
    v_lshlrev_b32 v214, 1, v212
    v_xor_b32 v213, v213, v214
    v_lshlrev_b32 v213, 4, v213
    v_and_b32 v214, 3, v255
    v_lshl_add_u32 v213, v214, 6, v213
    v_bfe_u32 v214, v255, 2, 2
    v_lshl_add_u32 v215, v214, 10, v213
    v_add_u32 v253, s34, v215
    v_lshl_add_u32 v213, v212, 12, v213
    v_bfe_u32 v214, v255, 3, 1
    v_lshl_add_u32 v250, v214, 10, v213
    v_bfe_u32 v212, v255, 4, 1
    v_and_b32 v213, 3, v255
    v_lshlrev_b32 v213, 3, v213
    v_lshl_add_u32 v213, v212, 12, v213
    v_bfe_u32 v214, v255, 5, 1
    v_lshl_add_u32 v213, v214, 10, v213
    v_bfe_u32 v214, v255, 2, 2
    v_lshl_add_u32 v213, v214, 6, v213
    v_add_u32 v213, 32768, v213
    v_lshl_add_u32 v251, v212, 5, v213
    v_xor_b32 v252, 32, v251
    s_mov_b32 m0, s24
    s_mov_b32 s30, 0
    buffer_load_dwordx4 v254, s[12:15], s30 offen offset:0 nt lds
    s_mov_b32 m0, s24
    s_mov_b32 s30, 0
    buffer_load_dwordx4 v254, s[12:15], s30 offen offset:1024 nt lds
    s_mov_b32 m0, s24
    s_mov_b32 s30, 0
    buffer_load_dwordx4 v254, s[12:15], s30 offen offset:2048 nt lds
    s_mov_b32 m0, s24
    s_mov_b32 s30, 0
    buffer_load_dwordx4 v254, s[12:15], s30 offen offset:3072 nt lds
    buffer_load_dwordx4 v[96:99], v236, s[4:7], s55 offen offset:0 nt
    s_add_u32 s31, s55, 4096
    buffer_load_dwordx4 v[100:103], v236, s[4:7], s31 offen offset:0 nt
    buffer_load_dwordx4 v[104:107], v236, s[4:7], s55 offen offset:128 nt
    s_add_u32 s31, s55, 4096
    buffer_load_dwordx4 v[108:111], v236, s[4:7], s31 offen offset:128 nt
    s_waitcnt vmcnt(18)
    v_mov_b32 v220, v64
    v_mov_b32 v221, v65
    v_mov_b32 v222, v66
    v_mov_b32 v223, v67
    v_mov_b32_dpp v64, v68 row_ror:8 row_mask:0xf bank_mask:0xc
    v_mov_b32_dpp v65, v69 row_ror:8 row_mask:0xf bank_mask:0xc
    v_mov_b32_dpp v66, v70 row_ror:8 row_mask:0xf bank_mask:0xc
    v_mov_b32_dpp v67, v71 row_ror:8 row_mask:0xf bank_mask:0xc
    v_mov_b32_dpp v68, v220 row_ror:8 row_mask:0xf bank_mask:0x3
    v_mov_b32_dpp v69, v221 row_ror:8 row_mask:0xf bank_mask:0x3
    v_mov_b32_dpp v70, v222 row_ror:8 row_mask:0xf bank_mask:0x3
    v_mov_b32_dpp v71, v223 row_ror:8 row_mask:0xf bank_mask:0x3
    s_waitcnt vmcnt(16)
    v_mov_b32 v220, v72
    v_mov_b32 v221, v73
    v_mov_b32 v222, v74
    v_mov_b32 v223, v75
    v_mov_b32_dpp v72, v76 row_ror:8 row_mask:0xf bank_mask:0xc
    v_mov_b32_dpp v73, v77 row_ror:8 row_mask:0xf bank_mask:0xc
    v_mov_b32_dpp v74, v78 row_ror:8 row_mask:0xf bank_mask:0xc
    v_mov_b32_dpp v75, v79 row_ror:8 row_mask:0xf bank_mask:0xc
    v_mov_b32_dpp v76, v220 row_ror:8 row_mask:0xf bank_mask:0x3
    v_mov_b32_dpp v77, v221 row_ror:8 row_mask:0xf bank_mask:0x3
    v_mov_b32_dpp v78, v222 row_ror:8 row_mask:0xf bank_mask:0x3
    v_mov_b32_dpp v79, v223 row_ror:8 row_mask:0xf bank_mask:0x3
    s_waitcnt vmcnt(14)
    v_mov_b32 v220, v80
    v_mov_b32 v221, v81
    v_mov_b32 v222, v82
    v_mov_b32 v223, v83
    v_mov_b32_dpp v80, v84 row_ror:8 row_mask:0xf bank_mask:0xc
    v_mov_b32_dpp v81, v85 row_ror:8 row_mask:0xf bank_mask:0xc
    v_mov_b32_dpp v82, v86 row_ror:8 row_mask:0xf bank_mask:0xc
    v_mov_b32_dpp v83, v87 row_ror:8 row_mask:0xf bank_mask:0xc
    v_mov_b32_dpp v84, v220 row_ror:8 row_mask:0xf bank_mask:0x3
    v_mov_b32_dpp v85, v221 row_ror:8 row_mask:0xf bank_mask:0x3
    v_mov_b32_dpp v86, v222 row_ror:8 row_mask:0xf bank_mask:0x3
    v_mov_b32_dpp v87, v223 row_ror:8 row_mask:0xf bank_mask:0x3
    s_waitcnt vmcnt(12)
    v_mov_b32 v220, v88
    v_mov_b32 v221, v89
    v_mov_b32 v222, v90
    v_mov_b32 v223, v91
    v_mov_b32_dpp v88, v92 row_ror:8 row_mask:0xf bank_mask:0xc
    v_mov_b32_dpp v89, v93 row_ror:8 row_mask:0xf bank_mask:0xc
    v_mov_b32_dpp v90, v94 row_ror:8 row_mask:0xf bank_mask:0xc
    v_mov_b32_dpp v91, v95 row_ror:8 row_mask:0xf bank_mask:0xc
    v_mov_b32_dpp v92, v220 row_ror:8 row_mask:0xf bank_mask:0x3
    v_mov_b32_dpp v93, v221 row_ror:8 row_mask:0xf bank_mask:0x3
    v_mov_b32_dpp v94, v222 row_ror:8 row_mask:0xf bank_mask:0x3
    v_mov_b32_dpp v95, v223 row_ror:8 row_mask:0xf bank_mask:0x3
    buffer_load_dwordx4 v[112:115], v236, s[4:7], s55 offen offset:256 nt
    s_add_u32 s31, s55, 4096
    buffer_load_dwordx4 v[116:119], v236, s[4:7], s31 offen offset:256 nt
    buffer_load_dwordx4 v[120:123], v236, s[4:7], s55 offen offset:384 nt
    s_add_u32 s31, s55, 4096
    buffer_load_dwordx4 v[124:127], v236, s[4:7], s31 offen offset:384 nt
    s_waitcnt vmcnt(8)
    s_barrier
    ds_read_b128 v[212:215], v250 offset:0
    ds_read_b128 v[216:219], v250 offset:2048
    ds_read_b128 v[220:223], v250 offset:256
    ds_read_b128 v[224:227], v250 offset:2304
    ds_read_b128 v[228:231], v250 offset:512
    ds_read_b128 v[232:235], v250 offset:2560
    ds_read_b128 a[192:195], v250 offset:768
    ds_read_b128 a[196:199], v250 offset:2816
    ds_read_b128 a[200:203], v250 offset:8192
    ds_read_b128 a[204:207], v250 offset:10240
    s_waitcnt lgkmcnt(9)
    v_mfma_f32_16x16x32_bf16 v[144:147], v[212:215], v[64:67], 0
    s_waitcnt lgkmcnt(8)
    ds_read_b128 a[208:211], v250 offset:8448
    v_mfma_f32_16x16x32_bf16 v[0:3], v[216:219], v[64:67], 0
    s_waitcnt lgkmcnt(8)
    ds_read_b128 a[212:215], v250 offset:10496
    v_mfma_f32_16x16x32_bf16 v[144:147], v[220:223], v[68:71], v[144:147]
    s_waitcnt lgkmcnt(8)
    ds_read_b128 a[216:219], v250 offset:8704
    buffer_load_dwordx4 v[128:131], v236, s[4:7], s56 offen offset:0 nt
    v_mfma_f32_16x16x32_bf16 v[0:3], v[224:227], v[68:71], v[0:3]
    s_waitcnt lgkmcnt(8)
    ds_read_b128 a[220:223], v250 offset:10752
    v_mfma_f32_16x16x32_bf16 v[144:147], v[228:231], v[72:75], v[144:147]
    s_waitcnt lgkmcnt(8)
    ds_read_b128 a[224:227], v250 offset:8960
    v_mfma_f32_16x16x32_bf16 v[0:3], v[232:235], v[72:75], v[0:3]
    s_waitcnt lgkmcnt(8)
    ds_read_b128 a[228:231], v250 offset:11008
    v_mfma_f32_16x16x32_bf16 v[144:147], a[192:195], v[76:79], v[144:147]
    s_waitcnt lgkmcnt(8)
    ds_read_b128 a[232:235], v250 offset:16384
    v_mfma_f32_16x16x32_bf16 v[0:3], a[196:199], v[76:79], v[0:3]
    s_waitcnt lgkmcnt(8)
    ds_read_b128 a[236:239], v250 offset:18432
    s_add_u32 s31, s56, 4096
    v_mfma_f32_16x16x32_bf16 v[144:147], a[200:203], v[80:83], v[144:147]
    s_waitcnt lgkmcnt(8)
    ds_read_b128 a[240:243], v250 offset:16640
    v_mfma_f32_16x16x32_bf16 v[0:3], a[204:207], v[80:83], v[0:3]
    s_waitcnt lgkmcnt(8)
    ds_read_b128 a[244:247], v250 offset:18688
    v_mfma_f32_16x16x32_bf16 v[144:147], a[208:211], v[84:87], v[144:147]
    s_waitcnt lgkmcnt(8)
    ds_read_b128 a[248:251], v250 offset:16896
    buffer_load_dwordx4 v[132:135], v236, s[4:7], s31 offen offset:0 nt
    v_mfma_f32_16x16x32_bf16 v[0:3], a[212:215], v[84:87], v[0:3]
    s_waitcnt lgkmcnt(8)
    ds_read_b128 a[252:255], v250 offset:18944
    v_mfma_f32_16x16x32_bf16 v[144:147], a[216:219], v[88:91], v[144:147]
    s_waitcnt lgkmcnt(8)
    ds_read_b128 v[212:215], v250 offset:17152
    v_mfma_f32_16x16x32_bf16 v[0:3], a[220:223], v[88:91], v[0:3]
    s_waitcnt lgkmcnt(8)
    ds_read_b128 v[216:219], v250 offset:19200
    v_mfma_f32_16x16x32_bf16 v[144:147], a[224:227], v[92:95], v[144:147]
    s_waitcnt lgkmcnt(8)
    ds_read_b128 v[220:223], v250 offset:24576
    v_mfma_f32_16x16x32_bf16 v[0:3], a[228:231], v[92:95], v[0:3]
    s_waitcnt lgkmcnt(8)
    ds_read_b128 v[224:227], v250 offset:26624
    buffer_load_dwordx4 v[136:139], v236, s[4:7], s56 offen offset:128 nt
    v_mfma_f32_16x16x32_bf16 v[148:151], a[232:235], v[64:67], 0
    s_waitcnt lgkmcnt(8)
    ds_read_b128 v[228:231], v250 offset:24832
    v_mfma_f32_16x16x32_bf16 v[152:155], a[236:239], v[64:67], 0
    s_waitcnt lgkmcnt(8)
    ds_read_b128 v[232:235], v250 offset:26880
    s_add_u32 s31, s56, 4096
    v_mfma_f32_16x16x32_bf16 v[148:151], a[240:243], v[68:71], v[148:151]
    s_waitcnt lgkmcnt(8)
    ds_read_b128 a[192:195], v250 offset:25088
    v_max3_f32 v16, v144, v145, v146
    v_mfma_f32_16x16x32_bf16 v[152:155], a[244:247], v[68:71], v[152:155]
    s_waitcnt lgkmcnt(8)
    ds_read_b128 a[196:199], v250 offset:27136
    v_max3_f32 v16, v16, v147, v0
    v_mfma_f32_16x16x32_bf16 v[148:151], a[248:251], v[72:75], v[148:151]
    s_waitcnt lgkmcnt(8)
    ds_read_b128 a[200:203], v250 offset:25344
    v_max3_f32 v16, v16, v1, v2
    v_mfma_f32_16x16x32_bf16 v[152:155], a[252:255], v[72:75], v[152:155]
    s_waitcnt lgkmcnt(8)
    ds_read_b128 a[204:207], v250 offset:27392
    v_max_f32 v16, v16, v3
    v_mfma_f32_16x16x32_bf16 v[148:151], v[212:215], v[76:79], v[148:151]
    s_waitcnt lgkmcnt(8)
    ds_read_b64_tr_b16 a[208:209], v251 offset:32768
    v_mov_b32 v245, v16
    v_mfma_f32_16x16x32_bf16 v[152:155], v[216:219], v[76:79], v[152:155]
    s_waitcnt lgkmcnt(8)
    ds_read_b64_tr_b16 a[210:211], v251 offset:34816
    v_permlane32_swap_b32 v16, v245
    v_mfma_f32_16x16x32_bf16 v[148:151], v[220:223], v[80:83], v[148:151]
    s_waitcnt lgkmcnt(8)
    ds_read_b64_tr_b16 a[212:213], v252 offset:32768
    v_max_f32 v16, v16, v245
    v_mfma_f32_16x16x32_bf16 v[152:155], v[224:227], v[80:83], v[152:155]
    s_waitcnt lgkmcnt(8)
    ds_read_b64_tr_b16 a[214:215], v252 offset:34816
    v_mov_b32 v245, v16
    v_mfma_f32_16x16x32_bf16 v[148:151], v[228:231], v[84:87], v[148:151]
    s_waitcnt lgkmcnt(8)
    ds_read_b64_tr_b16 a[216:217], v251 offset:33024
    v_permlane16_swap_b32 v16, v245
    v_mfma_f32_16x16x32_bf16 v[152:155], v[232:235], v[84:87], v[152:155]
    s_waitcnt lgkmcnt(8)
    ds_read_b64_tr_b16 a[218:219], v251 offset:35072
    v_max_f32 v16, v16, v245
    v_mfma_f32_16x16x32_bf16 v[148:151], a[192:195], v[88:91], v[148:151]
    s_waitcnt lgkmcnt(8)
    ds_read_b64_tr_b16 a[220:221], v252 offset:33024
    v_mul_f32_e64 v16, -v16, s26
    v_mfma_f32_16x16x32_bf16 v[152:155], a[196:199], v[88:91], v[152:155]
    s_waitcnt lgkmcnt(8)
    ds_read_b64_tr_b16 a[222:223], v252 offset:35072
    v_cndmask_b32 v240, v16, v240, s[42:43]
    v_mfma_f32_16x16x32_bf16 v[148:151], a[200:203], v[92:95], v[148:151]
    s_waitcnt lgkmcnt(8)
    ds_read_b64_tr_b16 a[224:225], v251 offset:33280
    v_mov_b32 v245, 0
    v_mfma_f32_16x16x32_bf16 v[152:155], a[204:207], v[92:95], v[152:155]
    ds_read_b64_tr_b16 a[226:227], v251 offset:35328
    buffer_load_dwordx4 v[140:143], v236, s[4:7], s31 offen offset:128 nt
    s_add_u32 m0, s34, 0
    s_mov_b32 s30, 16640
    buffer_load_dwordx4 v238, s[4:7], s30 offen offset:0 nt lds
    ds_read_b64_tr_b16 a[228:229], v252 offset:33280
    ds_read_b64_tr_b16 a[230:231], v252 offset:35328
    ds_read_b64_tr_b16 a[232:233], v251 offset:33536
    ds_read_b64_tr_b16 a[234:235], v251 offset:35584
    ds_read_b64_tr_b16 a[236:237], v252 offset:33536
    ds_read_b64_tr_b16 a[238:239], v252 offset:35584
    ds_read_b64_tr_b16 a[240:241], v251 offset:40960
    ds_read_b64_tr_b16 a[242:243], v251 offset:43008
    ds_read_b64_tr_b16 a[244:245], v252 offset:40960
    ds_read_b64_tr_b16 a[246:247], v252 offset:43008
    s_add_u32 m0, s34, 1024
    s_mov_b32 s30, 18688
    buffer_load_dwordx4 v239, s[4:7], s30 offen offset:0 nt lds
    ds_read_b64_tr_b16 a[248:249], v251 offset:41216
    ds_read_b64_tr_b16 a[250:251], v251 offset:43264
    ds_read_b64_tr_b16 a[252:253], v252 offset:41216
    ds_read_b64_tr_b16 a[254:255], v252 offset:43264
    v_fma_f32 v144, v144, s26, v240
    v_fma_f32 v145, v145, s26, v240
    v_fma_f32 v146, v146, s26, v240
    v_fma_f32 v147, v147, s26, v240
    v_fma_f32 v0, v0, s26, v240
    v_fma_f32 v1, v1, s26, v240
    v_fma_f32 v2, v2, s26, v240
    v_fma_f32 v3, v3, s26, v240
    v_exp_f32 v144, v144
    v_exp_f32 v145, v145
    v_exp_f32 v146, v146
    v_exp_f32 v147, v147
    v_exp_f32 v0, v0
    v_exp_f32 v1, v1
    v_exp_f32 v2, v2
    v_exp_f32 v3, v3
    v_add_f32 v245, v144, v245
    v_add_f32 v245, v145, v245
    v_add_f32 v245, v146, v245
    v_add_f32 v245, v147, v245
    v_add_f32 v245, v0, v245
    v_add_f32 v245, v1, v245
    v_add_f32 v245, v2, v245
    v_add_f32 v245, v3, v245
    v_cvt_pk_bf16_f32 v144, v144, v145
    v_cvt_pk_bf16_f32 v145, v146, v147
    v_cvt_pk_bf16_f32 v146, v0, v1
    v_cvt_pk_bf16_f32 v147, v2, v3
    v_fma_f32 v148, v148, s26, v240
    v_fma_f32 v149, v149, s26, v240
    s_waitcnt lgkmcnt(15)
    v_mfma_f32_16x16x32_bf16 v[0:3], a[208:211], v[144:147], 0
    ds_read_b64_tr_b16 v[212:213], v251 offset:41472
    v_fma_f32 v150, v150, s26, v240
    v_mfma_f32_16x16x32_bf16 v[4:7], a[212:215], v[144:147], 0
    ds_read_b64_tr_b16 v[214:215], v251 offset:43520
    s_add_u32 m0, s34, 2048
    v_mfma_f32_16x16x32_bf16 v[8:11], a[216:219], v[144:147], 0
    ds_read_b64_tr_b16 v[216:217], v252 offset:41472
    s_mov_b32 s30, 20736
    v_mfma_f32_16x16x32_bf16 v[12:15], a[220:223], v[144:147], 0
    s_waitcnt lgkmcnt(15)
    ds_read_b64_tr_b16 v[218:219], v252 offset:43520
    v_fma_f32 v151, v151, s26, v240
    v_mfma_f32_16x16x32_bf16 v[16:19], a[224:227], v[144:147], 0
    ds_read_b64_tr_b16 v[220:221], v251 offset:41728
    v_fma_f32 v152, v152, s26, v240
    v_mfma_f32_16x16x32_bf16 v[20:23], a[228:231], v[144:147], 0
    s_waitcnt lgkmcnt(15)
    ds_read_b64_tr_b16 v[222:223], v251 offset:43776
    v_fma_f32 v153, v153, s26, v240
    v_mfma_f32_16x16x32_bf16 v[24:27], a[232:235], v[144:147], 0
    s_waitcnt lgkmcnt(14)
    ds_read_b64_tr_b16 v[224:225], v252 offset:41728
    v_fma_f32 v154, v154, s26, v240
    v_mfma_f32_16x16x32_bf16 v[28:31], a[236:239], v[144:147], 0
    s_waitcnt lgkmcnt(13)
    ds_read_b64_tr_b16 v[226:227], v252 offset:43776
    v_fma_f32 v155, v155, s26, v240
    v_mfma_f32_16x16x32_bf16 v[32:35], a[240:243], v[144:147], 0
    s_waitcnt lgkmcnt(12)
    v_exp_f32 v148, v148
    v_mfma_f32_16x16x32_bf16 v[36:39], a[244:247], v[144:147], 0
    s_waitcnt lgkmcnt(10)
    v_exp_f32 v149, v149
    v_mfma_f32_16x16x32_bf16 v[40:43], a[248:251], v[144:147], 0
    s_waitcnt lgkmcnt(8)
    v_exp_f32 v150, v150
    v_mfma_f32_16x16x32_bf16 v[44:47], a[252:255], v[144:147], 0
    s_waitcnt lgkmcnt(6)
    v_exp_f32 v151, v151
    v_mfma_f32_16x16x32_bf16 v[48:51], v[212:215], v[144:147], 0
    s_waitcnt lgkmcnt(4)
    v_exp_f32 v152, v152
    v_mfma_f32_16x16x32_bf16 v[52:55], v[216:219], v[144:147], 0
    s_waitcnt lgkmcnt(2)
    v_exp_f32 v153, v153
    v_mfma_f32_16x16x32_bf16 v[56:59], v[220:223], v[144:147], 0
    s_waitcnt lgkmcnt(0)
    v_exp_f32 v154, v154
    v_mfma_f32_16x16x32_bf16 v[60:63], v[224:227], v[144:147], 0
    buffer_load_dwordx4 v238, s[4:7], s30 offen offset:0 nt lds
    s_add_u32 m0, s34, 3072
    s_mov_b32 s30, 22784
    buffer_load_dwordx4 v239, s[4:7], s30 offen offset:0 nt lds
    v_exp_f32 v155, v155
    v_add_f32 v245, v148, v245
    v_add_f32 v245, v149, v245
    v_add_f32 v245, v150, v245
    v_add_f32 v245, v151, v245
    v_add_f32 v245, v152, v245
    v_add_f32 v245, v153, v245
    v_add_f32 v245, v154, v245
    v_add_f32 v245, v155, v245
    v_cvt_pk_bf16_f32 v148, v148, v149
    v_cvt_pk_bf16_f32 v149, v150, v151
    v_cvt_pk_bf16_f32 v150, v152, v153
    v_cvt_pk_bf16_f32 v151, v154, v155
    ds_read_b128 v[212:215], v250 offset:0
    ds_read_b128 v[216:219], v250 offset:2048
    ds_read_b128 v[220:223], v250 offset:256
    ds_read_b128 v[224:227], v250 offset:2304
    ds_read_b128 v[228:231], v250 offset:512
    ds_read_b128 v[232:235], v250 offset:2560
    ds_read_b128 a[192:195], v250 offset:768
    ds_read_b128 a[196:199], v250 offset:2816
    ds_read_b128 a[200:203], v250 offset:8192
    ds_read_b128 a[204:207], v250 offset:10240
    ds_read_b128 a[208:211], v250 offset:8448
    ds_read_b128 a[212:215], v250 offset:10496
    s_waitcnt vmcnt(14)
    v_mov_b32 v200, v96
    v_mov_b32 v201, v97
    v_mov_b32 v202, v98
    v_mov_b32 v203, v99
    v_mov_b32_dpp v96, v100 row_ror:8 row_mask:0xf bank_mask:0xc
    v_mov_b32_dpp v97, v101 row_ror:8 row_mask:0xf bank_mask:0xc
    v_mov_b32_dpp v98, v102 row_ror:8 row_mask:0xf bank_mask:0xc
    v_mov_b32_dpp v99, v103 row_ror:8 row_mask:0xf bank_mask:0xc
    v_mov_b32_dpp v100, v200 row_ror:8 row_mask:0xf bank_mask:0x3
    v_mov_b32_dpp v101, v201 row_ror:8 row_mask:0xf bank_mask:0x3
    s_waitcnt lgkmcnt(11)
    v_mfma_f32_16x16x32_bf16 v[156:159], v[212:215], v[96:99], 0
    s_waitcnt lgkmcnt(10)
    ds_read_b128 a[216:219], v250 offset:8704
    v_mov_b32_dpp v102, v202 row_ror:8 row_mask:0xf bank_mask:0x3
    v_mfma_f32_16x16x32_bf16 v[204:207], v[216:219], v[96:99], 0
    ds_read_b128 a[220:223], v250 offset:10752
    v_mov_b32_dpp v103, v203 row_ror:8 row_mask:0xf bank_mask:0x3
    s_waitcnt vmcnt(12)
    ds_read_b128 a[224:227], v250 offset:8960
    s_waitcnt lgkmcnt(12)
    v_mfma_f32_16x16x32_bf16 v[156:159], v[220:223], v[100:103], v[156:159]
    s_waitcnt lgkmcnt(11)
    ds_read_b128 a[228:231], v250 offset:11008
    s_add_u32 m0, s34, 4096
    v_mfma_f32_16x16x32_bf16 v[204:207], v[224:227], v[100:103], v[204:207]
    ds_read_b128 a[232:235], v250 offset:16384
    s_mov_b32 s30, 24576
    buffer_load_dwordx4 v238, s[4:7], s30 offen offset:0 nt lds
    v_mov_b32 v200, v104
    v_mov_b32 v201, v105
    v_mov_b32 v202, v106
    v_mov_b32 v203, v107
    v_mov_b32_dpp v104, v108 row_ror:8 row_mask:0xf bank_mask:0xc
    v_mov_b32_dpp v105, v109 row_ror:8 row_mask:0xf bank_mask:0xc
    v_mov_b32_dpp v106, v110 row_ror:8 row_mask:0xf bank_mask:0xc
    v_mov_b32_dpp v107, v111 row_ror:8 row_mask:0xf bank_mask:0xc
    v_mov_b32_dpp v108, v200 row_ror:8 row_mask:0xf bank_mask:0x3
    v_mov_b32_dpp v109, v201 row_ror:8 row_mask:0xf bank_mask:0x3
    s_waitcnt lgkmcnt(12)
    v_mfma_f32_16x16x32_bf16 v[156:159], v[228:231], v[104:107], v[156:159]
    s_waitcnt lgkmcnt(11)
    ds_read_b128 a[236:239], v250 offset:18432
    v_mov_b32_dpp v110, v202 row_ror:8 row_mask:0xf bank_mask:0x3
    v_mfma_f32_16x16x32_bf16 v[204:207], v[232:235], v[104:107], v[204:207]
    ds_read_b128 a[240:243], v250 offset:16640
    v_mov_b32_dpp v111, v203 row_ror:8 row_mask:0xf bank_mask:0x3
    s_waitcnt vmcnt(11)
    ds_read_b128 a[244:247], v250 offset:18688
    s_waitcnt lgkmcnt(13)
    v_mfma_f32_16x16x32_bf16 v[156:159], a[192:195], v[108:111], v[156:159]
    s_waitcnt lgkmcnt(12)
    ds_read_b128 a[248:251], v250 offset:16896
    v_mov_b32 v200, v112
    v_mfma_f32_16x16x32_bf16 v[204:207], a[196:199], v[108:111], v[204:207]
    ds_read_b128 a[252:255], v250 offset:18944
    v_mov_b32 v201, v113
    v_mov_b32 v202, v114
    v_mov_b32 v203, v115
    v_mov_b32_dpp v112, v116 row_ror:8 row_mask:0xf bank_mask:0xc
    v_mov_b32_dpp v113, v117 row_ror:8 row_mask:0xf bank_mask:0xc
    v_mov_b32_dpp v114, v118 row_ror:8 row_mask:0xf bank_mask:0xc
    v_mov_b32_dpp v115, v119 row_ror:8 row_mask:0xf bank_mask:0xc
    s_add_u32 m0, s34, 5120
    s_mov_b32 s30, 26624
    s_waitcnt lgkmcnt(13)
    v_mfma_f32_16x16x32_bf16 v[156:159], a[200:203], v[112:115], v[156:159]
    s_waitcnt lgkmcnt(12)
    ds_read_b128 v[212:215], v250 offset:17152
    v_mov_b32_dpp v116, v200 row_ror:8 row_mask:0xf bank_mask:0x3
    v_mfma_f32_16x16x32_bf16 v[204:207], a[204:207], v[112:115], v[204:207]
    ds_read_b128 v[216:219], v250 offset:19200
    buffer_load_dwordx4 v239, s[4:7], s30 offen offset:0 nt lds
    v_mov_b32_dpp v117, v201 row_ror:8 row_mask:0xf bank_mask:0x3
    v_mov_b32_dpp v118, v202 row_ror:8 row_mask:0xf bank_mask:0x3
    v_mov_b32_dpp v119, v203 row_ror:8 row_mask:0xf bank_mask:0x3
    s_waitcnt vmcnt(10)
    v_mov_b32 v200, v120
    s_waitcnt lgkmcnt(13)
    v_mfma_f32_16x16x32_bf16 v[156:159], a[208:211], v[116:119], v[156:159]
    s_waitcnt lgkmcnt(12)
    ds_read_b128 v[220:223], v250 offset:24576
    v_mov_b32 v201, v121
    v_mfma_f32_16x16x32_bf16 v[204:207], a[212:215], v[116:119], v[204:207]
    ds_read_b128 v[224:227], v250 offset:26624
    v_mov_b32 v202, v122
    v_mov_b32 v203, v123
    v_mov_b32_dpp v120, v124 row_ror:8 row_mask:0xf bank_mask:0xc
    v_mov_b32_dpp v121, v125 row_ror:8 row_mask:0xf bank_mask:0xc
    v_mov_b32_dpp v122, v126 row_ror:8 row_mask:0xf bank_mask:0xc
    v_mov_b32_dpp v123, v127 row_ror:8 row_mask:0xf bank_mask:0xc
    v_mov_b32_dpp v124, v200 row_ror:8 row_mask:0xf bank_mask:0x3
    v_mov_b32_dpp v125, v201 row_ror:8 row_mask:0xf bank_mask:0x3
    s_waitcnt lgkmcnt(13)
    v_mfma_f32_16x16x32_bf16 v[156:159], a[216:219], v[120:123], v[156:159]
    s_waitcnt lgkmcnt(12)
    ds_read_b128 v[228:231], v250 offset:24832
    s_add_u32 m0, s34, 6144
    v_mfma_f32_16x16x32_bf16 v[204:207], a[220:223], v[120:123], v[204:207]
    ds_read_b128 v[232:235], v250 offset:26880
    s_mov_b32 s30, 28672
    buffer_load_dwordx4 v238, s[4:7], s30 offen offset:0 nt lds
    v_mov_b32_dpp v126, v202 row_ror:8 row_mask:0xf bank_mask:0x3
    v_mov_b32_dpp v127, v203 row_ror:8 row_mask:0xf bank_mask:0x3
    s_waitcnt lgkmcnt(13)
    s_nop 0
    v_mfma_f32_16x16x32_bf16 v[156:159], a[224:227], v[124:127], v[156:159]
    s_waitcnt lgkmcnt(12)
    ds_read_b128 a[192:195], v250 offset:25088
    v_mfma_f32_16x16x32_bf16 v[204:207], a[228:231], v[124:127], v[204:207]
    s_waitcnt lgkmcnt(12)
    ds_read_b128 a[196:199], v250 offset:27136
    v_mfma_f32_16x16x32_bf16 v[160:163], a[232:235], v[96:99], 0
    s_waitcnt lgkmcnt(12)
    ds_read_b128 a[200:203], v250 offset:25344
    v_mfma_f32_16x16x32_bf16 v[164:167], a[236:239], v[96:99], 0
    s_waitcnt lgkmcnt(12)
    ds_read_b128 a[204:207], v250 offset:27392
    s_add_u32 m0, s34, 7168
    v_mfma_f32_16x16x32_bf16 v[160:163], a[240:243], v[100:103], v[160:163]
    s_waitcnt lgkmcnt(12)
    ds_read_b64_tr_b16 a[208:209], v251 offset:32768
    s_mov_b32 s30, 30720
    v_mfma_f32_16x16x32_bf16 v[164:167], a[244:247], v[100:103], v[164:167]
    s_waitcnt lgkmcnt(12)
    ds_read_b64_tr_b16 a[210:211], v251 offset:34816
    v_max3_f32 v144, v156, v157, v158
    v_mfma_f32_16x16x32_bf16 v[160:163], a[248:251], v[104:107], v[160:163]
    s_waitcnt lgkmcnt(12)
    ds_read_b64_tr_b16 a[212:213], v252 offset:32768
    v_max3_f32 v144, v144, v159, v204
    v_mfma_f32_16x16x32_bf16 v[164:167], a[252:255], v[104:107], v[164:167]
    s_waitcnt lgkmcnt(12)
    ds_read_b64_tr_b16 a[214:215], v252 offset:34816
    v_max3_f32 v144, v144, v205, v206
    v_mfma_f32_16x16x32_bf16 v[160:163], v[212:215], v[108:111], v[160:163]
    s_waitcnt lgkmcnt(12)
    ds_read_b64_tr_b16 a[216:217], v251 offset:33024
    v_max_f32 v144, v144, v207
    v_mfma_f32_16x16x32_bf16 v[164:167], v[216:219], v[108:111], v[164:167]
    s_waitcnt lgkmcnt(12)
    ds_read_b64_tr_b16 a[218:219], v251 offset:35072
    v_mov_b32 v246, v144
    v_mfma_f32_16x16x32_bf16 v[160:163], v[220:223], v[112:115], v[160:163]
    s_waitcnt lgkmcnt(12)
    ds_read_b64_tr_b16 a[220:221], v252 offset:33024
    v_permlane32_swap_b32 v144, v246
    v_mfma_f32_16x16x32_bf16 v[164:167], v[224:227], v[112:115], v[164:167]
    s_waitcnt lgkmcnt(12)
    ds_read_b64_tr_b16 a[222:223], v252 offset:35072
    v_max_f32 v144, v144, v246
    v_mfma_f32_16x16x32_bf16 v[160:163], v[228:231], v[116:119], v[160:163]
    s_waitcnt lgkmcnt(12)
    ds_read_b64_tr_b16 a[224:225], v251 offset:33280
    v_mov_b32 v246, v144
    v_mfma_f32_16x16x32_bf16 v[164:167], v[232:235], v[116:119], v[164:167]
    s_waitcnt lgkmcnt(12)
    ds_read_b64_tr_b16 a[226:227], v251 offset:35328
    v_permlane16_swap_b32 v144, v246
    v_mfma_f32_16x16x32_bf16 v[160:163], a[192:195], v[120:123], v[160:163]
    s_waitcnt lgkmcnt(12)
    ds_read_b64_tr_b16 a[228:229], v252 offset:33280
    v_max_f32 v144, v144, v246
    v_mfma_f32_16x16x32_bf16 v[164:167], a[196:199], v[120:123], v[164:167]
    s_waitcnt lgkmcnt(12)
    ds_read_b64_tr_b16 a[230:231], v252 offset:35328
    v_mul_f32_e64 v144, -v144, s26
    v_mfma_f32_16x16x32_bf16 v[160:163], a[200:203], v[124:127], v[160:163]
    s_waitcnt lgkmcnt(12)
    ds_read_b64_tr_b16 a[232:233], v251 offset:33536
    v_cndmask_b32 v241, v144, v241, s[42:43]
    v_mfma_f32_16x16x32_bf16 v[164:167], a[204:207], v[124:127], v[164:167]
    ds_read_b64_tr_b16 a[234:235], v251 offset:35584
    buffer_load_dwordx4 v239, s[4:7], s30 offen offset:0 nt lds
    s_add_u32 m0, s34, 8192
    s_mov_b32 s30, 24832
    buffer_load_dwordx4 v238, s[4:7], s30 offen offset:0 nt lds
    ds_read_b64_tr_b16 a[236:237], v252 offset:33536
    ds_read_b64_tr_b16 a[238:239], v252 offset:35584
    ds_read_b64_tr_b16 a[240:241], v251 offset:40960
    ds_read_b64_tr_b16 a[242:243], v251 offset:43008
    ds_read_b64_tr_b16 a[244:245], v252 offset:40960
    ds_read_b64_tr_b16 a[246:247], v252 offset:43008
    s_add_u32 m0, s34, 9216
    s_mov_b32 s30, 26880
    buffer_load_dwordx4 v239, s[4:7], s30 offen offset:0 nt lds
    ds_read_b64_tr_b16 a[248:249], v251 offset:41216
    ds_read_b64_tr_b16 a[250:251], v251 offset:43264
    ds_read_b64_tr_b16 a[252:253], v252 offset:41216
    ds_read_b64_tr_b16 a[254:255], v252 offset:43264
    v_mov_b32 v246, 0
    v_fma_f32 v156, v156, s26, v241
    v_fma_f32 v157, v157, s26, v241
    v_fma_f32 v158, v158, s26, v241
    v_fma_f32 v159, v159, s26, v241
    v_fma_f32 v204, v204, s26, v241
    v_fma_f32 v205, v205, s26, v241
    v_fma_f32 v206, v206, s26, v241
    v_fma_f32 v207, v207, s26, v241
    v_exp_f32 v156, v156
    v_exp_f32 v157, v157
    v_exp_f32 v158, v158
    v_exp_f32 v159, v159
    v_exp_f32 v204, v204
    v_exp_f32 v205, v205
    v_exp_f32 v206, v206
    v_exp_f32 v207, v207
    v_add_f32 v246, v156, v246
    v_add_f32 v246, v157, v246
    v_add_f32 v246, v158, v246
    v_add_f32 v246, v159, v246
    v_cvt_pk_bf16_f32 v156, v156, v157
    v_cvt_pk_bf16_f32 v157, v158, v159
    v_cvt_pk_bf16_f32 v158, v204, v205
    v_cvt_pk_bf16_f32 v159, v206, v207
    v_add_f32 v246, v204, v246
    v_add_f32 v246, v205, v246
    s_waitcnt lgkmcnt(15)
    v_mfma_f32_16x16x32_bf16 a[0:3], a[208:211], v[156:159], 0
    ds_read_b64_tr_b16 v[212:213], v251 offset:41472
    v_add_f32 v246, v206, v246
    v_mfma_f32_16x16x32_bf16 a[4:7], a[212:215], v[156:159], 0
    ds_read_b64_tr_b16 v[214:215], v251 offset:43520
    s_add_u32 m0, s34, 10240
    v_mfma_f32_16x16x32_bf16 a[8:11], a[216:219], v[156:159], 0
    ds_read_b64_tr_b16 v[216:217], v252 offset:41472
    s_mov_b32 s30, 28928
    v_mfma_f32_16x16x32_bf16 a[12:15], a[220:223], v[156:159], 0
    s_waitcnt lgkmcnt(15)
    ds_read_b64_tr_b16 v[218:219], v252 offset:43520
    v_add_f32 v246, v207, v246
    v_mfma_f32_16x16x32_bf16 a[16:19], a[224:227], v[156:159], 0
    ds_read_b64_tr_b16 v[220:221], v251 offset:41728
    v_fma_f32 v160, v160, s26, v241
    v_mfma_f32_16x16x32_bf16 a[20:23], a[228:231], v[156:159], 0
    s_waitcnt lgkmcnt(15)
    ds_read_b64_tr_b16 v[222:223], v251 offset:43776
    v_fma_f32 v161, v161, s26, v241
    v_mfma_f32_16x16x32_bf16 a[24:27], a[232:235], v[156:159], 0
    s_waitcnt lgkmcnt(14)
    ds_read_b64_tr_b16 v[224:225], v252 offset:41728
    v_fma_f32 v162, v162, s26, v241
    v_mfma_f32_16x16x32_bf16 a[28:31], a[236:239], v[156:159], 0
    s_waitcnt lgkmcnt(13)
    ds_read_b64_tr_b16 v[226:227], v252 offset:43776
    v_fma_f32 v163, v163, s26, v241
    v_mfma_f32_16x16x32_bf16 a[32:35], a[240:243], v[156:159], 0
    s_waitcnt lgkmcnt(12)
    v_fma_f32 v164, v164, s26, v241
    v_fma_f32 v165, v165, s26, v241
    v_mfma_f32_16x16x32_bf16 a[36:39], a[244:247], v[156:159], 0
    s_waitcnt lgkmcnt(10)
    v_fma_f32 v166, v166, s26, v241
    v_fma_f32 v167, v167, s26, v241
    v_mfma_f32_16x16x32_bf16 a[40:43], a[248:251], v[156:159], 0
    s_waitcnt lgkmcnt(8)
    v_exp_f32 v160, v160
    v_mfma_f32_16x16x32_bf16 a[44:47], a[252:255], v[156:159], 0
    s_waitcnt lgkmcnt(6)
    v_exp_f32 v161, v161
    v_mfma_f32_16x16x32_bf16 a[48:51], v[212:215], v[156:159], 0
    s_waitcnt lgkmcnt(4)
    v_exp_f32 v162, v162
    v_mfma_f32_16x16x32_bf16 a[52:55], v[216:219], v[156:159], 0
    s_waitcnt lgkmcnt(2)
    v_exp_f32 v163, v163
    v_mfma_f32_16x16x32_bf16 a[56:59], v[220:223], v[156:159], 0
    s_waitcnt lgkmcnt(0)
    v_exp_f32 v164, v164
    v_mfma_f32_16x16x32_bf16 a[60:63], v[224:227], v[156:159], 0
    buffer_load_dwordx4 v238, s[4:7], s30 offen offset:0 nt lds
    s_add_u32 m0, s34, 11264
    s_mov_b32 s30, 30976
    buffer_load_dwordx4 v239, s[4:7], s30 offen offset:0 nt lds
    v_exp_f32 v165, v165
    v_exp_f32 v166, v166
    v_exp_f32 v167, v167
    v_add_f32 v246, v160, v246
    v_add_f32 v246, v161, v246
    v_add_f32 v246, v162, v246
    v_add_f32 v246, v163, v246
    v_add_f32 v246, v164, v246
    v_add_f32 v246, v165, v246
    v_add_f32 v246, v166, v246
    v_add_f32 v246, v167, v246
    v_cvt_pk_bf16_f32 v160, v160, v161
    v_cvt_pk_bf16_f32 v161, v162, v163
    v_cvt_pk_bf16_f32 v162, v164, v165
    v_cvt_pk_bf16_f32 v163, v166, v167
    ds_read_b128 v[212:215], v250 offset:0
    ds_read_b128 v[216:219], v250 offset:2048
    ds_read_b128 v[220:223], v250 offset:256
    ds_read_b128 v[224:227], v250 offset:2304
    ds_read_b128 v[228:231], v250 offset:512
    ds_read_b128 v[232:235], v250 offset:2560
    ds_read_b128 a[192:195], v250 offset:768
    ds_read_b128 a[196:199], v250 offset:2816
    ds_read_b128 a[200:203], v250 offset:8192
    ds_read_b128 a[208:211], v250 offset:10240
    ds_read_b128 a[212:215], v250 offset:8448
    ds_read_b128 a[220:223], v250 offset:10496
    s_waitcnt vmcnt(14)
    v_mov_b32 v200, v128
    v_mov_b32 v201, v129
    v_mov_b32 v202, v130
    v_mov_b32 v203, v131
    v_mov_b32_dpp v128, v132 row_ror:8 row_mask:0xf bank_mask:0xc
    v_mov_b32_dpp v129, v133 row_ror:8 row_mask:0xf bank_mask:0xc
    v_mov_b32_dpp v130, v134 row_ror:8 row_mask:0xf bank_mask:0xc
    v_mov_b32_dpp v131, v135 row_ror:8 row_mask:0xf bank_mask:0xc
    v_mov_b32_dpp v132, v200 row_ror:8 row_mask:0xf bank_mask:0x3
    v_mov_b32_dpp v133, v201 row_ror:8 row_mask:0xf bank_mask:0x3
    s_waitcnt lgkmcnt(11)
    v_mfma_f32_16x16x32_bf16 v[168:171], v[212:215], v[128:131], 0
    s_waitcnt lgkmcnt(10)
    ds_read_b128 a[224:227], v250 offset:8704
    v_mov_b32_dpp v134, v202 row_ror:8 row_mask:0xf bank_mask:0x3
    v_mfma_f32_16x16x32_bf16 v[204:207], v[216:219], v[128:131], 0
    ds_read_b128 a[232:235], v250 offset:10752
    v_mov_b32_dpp v135, v203 row_ror:8 row_mask:0xf bank_mask:0x3
    s_waitcnt vmcnt(12)
    ds_read_b128 a[236:239], v250 offset:8960
    s_waitcnt lgkmcnt(12)
    v_mfma_f32_16x16x32_bf16 v[168:171], v[220:223], v[132:135], v[168:171]
    s_waitcnt lgkmcnt(11)
    ds_read_b128 a[244:247], v250 offset:11008
    s_add_u32 m0, s34, 12288
    v_mfma_f32_16x16x32_bf16 v[204:207], v[224:227], v[132:135], v[204:207]
    ds_read_b128 a[248:251], v250 offset:16384
    s_mov_b32 s30, 32768
    buffer_load_dwordx4 v238, s[4:7], s30 offen offset:0 nt lds
    v_mov_b32 v200, v136
    v_mov_b32 v201, v137
    v_mov_b32 v202, v138
    v_mov_b32 v203, v139
    v_mov_b32_dpp v136, v140 row_ror:8 row_mask:0xf bank_mask:0xc
    v_mov_b32_dpp v137, v141 row_ror:8 row_mask:0xf bank_mask:0xc
    v_mov_b32_dpp v138, v142 row_ror:8 row_mask:0xf bank_mask:0xc
    v_mov_b32_dpp v139, v143 row_ror:8 row_mask:0xf bank_mask:0xc
    v_mov_b32_dpp v140, v200 row_ror:8 row_mask:0xf bank_mask:0x3
    v_mov_b32_dpp v141, v201 row_ror:8 row_mask:0xf bank_mask:0x3
    s_waitcnt lgkmcnt(12)
    v_mfma_f32_16x16x32_bf16 v[168:171], v[228:231], v[136:139], v[168:171]
    s_waitcnt lgkmcnt(11)
    ds_read_b128 a[252:255], v250 offset:18432
    v_mov_b32_dpp v142, v202 row_ror:8 row_mask:0xf bank_mask:0x3
    v_mfma_f32_16x16x32_bf16 v[204:207], v[232:235], v[136:139], v[204:207]
    ds_read_b128 v[212:215], v250 offset:16640
    v_mov_b32_dpp v143, v203 row_ror:8 row_mask:0xf bank_mask:0x3
    s_waitcnt vmcnt(9)
    ds_read_b128 a[204:207], v253 offset:0
    s_waitcnt lgkmcnt(13)
    v_mfma_f32_16x16x32_bf16 v[168:171], a[192:195], v[140:143], v[168:171]
    s_waitcnt lgkmcnt(12)
    ds_read_b128 a[216:219], v253 offset:256
    ds_read_b128 a[228:231], v253 offset:512
    v_mfma_f32_16x16x32_bf16 v[204:207], a[196:199], v[140:143], v[204:207]
    ds_read_b128 a[240:243], v253 offset:768
    ds_read_b128 v[216:219], v250 offset:18688
    ds_read_b128 v[220:223], v250 offset:16896
    s_add_u32 m0, s34, 13312
    s_mov_b32 s30, 34816
    buffer_load_dwordx4 v239, s[4:7], s30 offen offset:0 nt lds
    ds_read_b128 v[224:227], v250 offset:18944
    ds_read_b128 v[228:231], v250 offset:17152
    ds_read_b128 v[232:235], v250 offset:19200
    ds_read_b128 a[192:195], v250 offset:24576
    s_waitcnt lgkmcnt(9)
    v_mfma_f32_16x16x32_bf16 v[168:171], a[200:203], a[204:207], v[168:171]
    ds_read_b128 a[196:199], v250 offset:26624
    v_mfma_f32_16x16x32_bf16 v[204:207], a[208:211], a[204:207], v[204:207]
    s_waitcnt lgkmcnt(9)
    ds_read_b128 a[200:203], v250 offset:24832
    v_mfma_f32_16x16x32_bf16 v[168:171], a[212:215], a[216:219], v[168:171]
    ds_read_b128 a[208:211], v250 offset:26880
    v_mfma_f32_16x16x32_bf16 v[204:207], a[220:223], a[216:219], v[204:207]
    s_waitcnt lgkmcnt(10)
    ds_read_b128 a[212:215], v250 offset:25088
    v_mfma_f32_16x16x32_bf16 v[168:171], a[224:227], a[228:231], v[168:171]
    ds_read_b128 a[220:223], v250 offset:27136
    s_add_u32 m0, s34, 14336
    v_mfma_f32_16x16x32_bf16 v[204:207], a[232:235], a[228:231], v[204:207]
    s_waitcnt lgkmcnt(11)
    ds_read_b128 a[224:227], v250 offset:25344
    s_mov_b32 s30, 36864
    v_mfma_f32_16x16x32_bf16 v[168:171], a[236:239], a[240:243], v[168:171]
    ds_read_b128 a[232:235], v250 offset:27392
    buffer_load_dwordx4 v238, s[4:7], s30 offen offset:0 nt lds
    v_mfma_f32_16x16x32_bf16 v[204:207], a[244:247], a[240:243], v[204:207]
    ds_read_b64_tr_b16 a[236:237], v251 offset:32768
    v_mfma_f32_16x16x32_bf16 v[172:175], a[248:251], v[128:131], 0
    ds_read_b64_tr_b16 a[238:239], v251 offset:34816
    v_mfma_f32_16x16x32_bf16 v[176:179], a[252:255], v[128:131], 0
    ds_read_b64_tr_b16 a[244:245], v252 offset:32768
    s_add_u32 m0, s34, 15360
    v_mfma_f32_16x16x32_bf16 v[172:175], v[212:215], v[132:135], v[172:175]
    s_waitcnt lgkmcnt(15)
    ds_read_b64_tr_b16 a[246:247], v252 offset:34816
    s_mov_b32 s30, 38912
    v_mfma_f32_16x16x32_bf16 v[176:179], v[216:219], v[132:135], v[176:179]
    s_waitcnt lgkmcnt(15)
    ds_read_b64_tr_b16 a[248:249], v251 offset:33024
    v_max3_f32 v144, v168, v169, v170
    v_mfma_f32_16x16x32_bf16 v[172:175], v[220:223], v[136:139], v[172:175]
    s_waitcnt lgkmcnt(15)
    ds_read_b64_tr_b16 a[250:251], v251 offset:35072
    v_max3_f32 v144, v144, v171, v204
    v_mfma_f32_16x16x32_bf16 v[176:179], v[224:227], v[136:139], v[176:179]
    s_waitcnt lgkmcnt(15)
    ds_read_b64_tr_b16 a[252:253], v252 offset:33024
    v_max3_f32 v144, v144, v205, v206
    v_mfma_f32_16x16x32_bf16 v[172:175], v[228:231], v[140:143], v[172:175]
    s_waitcnt lgkmcnt(15)
    ds_read_b64_tr_b16 a[254:255], v252 offset:35072
    v_max_f32 v144, v144, v207
    v_mfma_f32_16x16x32_bf16 v[176:179], v[232:235], v[140:143], v[176:179]
    s_waitcnt lgkmcnt(15)
    ds_read_b64_tr_b16 v[212:213], v251 offset:33280
    v_mov_b32 v247, v144
    v_mfma_f32_16x16x32_bf16 v[172:175], a[192:195], a[204:207], v[172:175]
    s_waitcnt lgkmcnt(15)
    ds_read_b64_tr_b16 v[214:215], v251 offset:35328
    v_permlane32_swap_b32 v144, v247
    v_mfma_f32_16x16x32_bf16 v[176:179], a[196:199], a[204:207], v[176:179]
    s_waitcnt lgkmcnt(15)
    ds_read_b64_tr_b16 v[216:217], v252 offset:33280
    v_max_f32 v144, v144, v247
    v_mfma_f32_16x16x32_bf16 v[172:175], a[200:203], a[216:219], v[172:175]
    s_waitcnt lgkmcnt(15)
    ds_read_b64_tr_b16 v[218:219], v252 offset:35328
    v_mov_b32 v247, v144
    v_mfma_f32_16x16x32_bf16 v[176:179], a[208:211], a[216:219], v[176:179]
    s_waitcnt lgkmcnt(15)
    ds_read_b64_tr_b16 v[220:221], v251 offset:33536
    v_permlane16_swap_b32 v144, v247
    v_mfma_f32_16x16x32_bf16 v[172:175], a[212:215], a[228:231], v[172:175]
    s_waitcnt lgkmcnt(15)
    ds_read_b64_tr_b16 v[222:223], v251 offset:35584
    v_max_f32 v144, v144, v247
    v_mfma_f32_16x16x32_bf16 v[176:179], a[220:223], a[228:231], v[176:179]
    s_waitcnt lgkmcnt(15)
    ds_read_b64_tr_b16 v[224:225], v252 offset:33536
    v_mul_f32_e64 v144, -v144, s26
    v_mfma_f32_16x16x32_bf16 v[172:175], a[224:227], a[240:243], v[172:175]
    s_waitcnt lgkmcnt(15)
    ds_read_b64_tr_b16 v[226:227], v252 offset:35584
    v_cndmask_b32 v242, v144, v242, s[42:43]
    v_mfma_f32_16x16x32_bf16 v[176:179], a[232:235], a[240:243], v[176:179]
    ds_read_b64_tr_b16 v[228:229], v251 offset:40960
    buffer_load_dwordx4 v239, s[4:7], s30 offen offset:0 nt lds
    s_add_u32 m0, s34, 16384
    s_mov_b32 s30, 33024
    buffer_load_dwordx4 v238, s[4:7], s30 offen offset:0 nt lds
    ds_read_b64_tr_b16 v[230:231], v251 offset:43008
    ds_read_b64_tr_b16 v[232:233], v252 offset:40960
    ds_read_b64_tr_b16 v[234:235], v252 offset:43008
    s_add_u32 m0, s34, 17408
    s_mov_b32 s30, 35072
    buffer_load_dwordx4 v239, s[4:7], s30 offen offset:0 nt lds
    ds_read_b64_tr_b16 a[192:193], v251 offset:41216
    ds_read_b64_tr_b16 a[194:195], v251 offset:43264
    ds_read_b64_tr_b16 a[196:197], v252 offset:41216
    ds_read_b64_tr_b16 a[198:199], v252 offset:43264
    v_mov_b32 v247, 0
    v_fma_f32 v168, v168, s26, v242
    v_fma_f32 v169, v169, s26, v242
    v_fma_f32 v170, v170, s26, v242
    v_fma_f32 v171, v171, s26, v242
    v_fma_f32 v204, v204, s26, v242
    v_fma_f32 v205, v205, s26, v242
    v_fma_f32 v206, v206, s26, v242
    v_fma_f32 v207, v207, s26, v242
    v_exp_f32 v168, v168
    v_exp_f32 v169, v169
    v_exp_f32 v170, v170
    v_exp_f32 v171, v171
    v_exp_f32 v204, v204
    v_exp_f32 v205, v205
    v_exp_f32 v206, v206
    v_exp_f32 v207, v207
    v_add_f32 v247, v168, v247
    v_add_f32 v247, v169, v247
    v_add_f32 v247, v170, v247
    v_add_f32 v247, v171, v247
    v_cvt_pk_bf16_f32 v168, v168, v169
    v_cvt_pk_bf16_f32 v169, v170, v171
    v_cvt_pk_bf16_f32 v170, v204, v205
    v_cvt_pk_bf16_f32 v171, v206, v207
    v_add_f32 v247, v204, v247
    v_add_f32 v247, v205, v247
    s_waitcnt lgkmcnt(15)
    v_mfma_f32_16x16x32_bf16 a[64:67], a[236:239], v[168:171], 0
    ds_read_b64_tr_b16 a[204:205], v251 offset:41472
    v_add_f32 v247, v206, v247
    v_mfma_f32_16x16x32_bf16 a[68:71], a[244:247], v[168:171], 0
    ds_read_b64_tr_b16 a[206:207], v251 offset:43520
    s_add_u32 m0, s34, 18432
    v_mfma_f32_16x16x32_bf16 a[72:75], a[248:251], v[168:171], 0
    ds_read_b64_tr_b16 a[200:201], v252 offset:41472
    s_mov_b32 s30, 37120
    v_mfma_f32_16x16x32_bf16 a[76:79], a[252:255], v[168:171], 0
    s_waitcnt lgkmcnt(15)
    ds_read_b64_tr_b16 a[202:203], v252 offset:43520
    v_add_f32 v247, v207, v247
    v_mfma_f32_16x16x32_bf16 a[80:83], v[212:215], v[168:171], 0
    ds_read_b64_tr_b16 a[208:209], v251 offset:41728
    v_fma_f32 v172, v172, s26, v242
    v_mfma_f32_16x16x32_bf16 a[84:87], v[216:219], v[168:171], 0
    s_waitcnt lgkmcnt(15)
    ds_read_b64_tr_b16 a[210:211], v251 offset:43776
    v_fma_f32 v173, v173, s26, v242
    v_mfma_f32_16x16x32_bf16 a[88:91], v[220:223], v[168:171], 0
    s_waitcnt lgkmcnt(14)
    ds_read_b64_tr_b16 a[216:217], v252 offset:41728
    v_fma_f32 v174, v174, s26, v242
    v_mfma_f32_16x16x32_bf16 a[92:95], v[224:227], v[168:171], 0
    s_waitcnt lgkmcnt(13)
    ds_read_b64_tr_b16 a[218:219], v252 offset:43776
    v_fma_f32 v175, v175, s26, v242
    v_mfma_f32_16x16x32_bf16 a[96:99], v[228:231], v[168:171], 0
    s_waitcnt lgkmcnt(12)
    v_fma_f32 v176, v176, s26, v242
    v_fma_f32 v177, v177, s26, v242
    v_mfma_f32_16x16x32_bf16 a[100:103], v[232:235], v[168:171], 0
    s_waitcnt lgkmcnt(10)
    v_fma_f32 v178, v178, s26, v242
    v_fma_f32 v179, v179, s26, v242
    v_mfma_f32_16x16x32_bf16 a[104:107], a[192:195], v[168:171], 0
    s_waitcnt lgkmcnt(8)
    v_exp_f32 v172, v172
    v_mfma_f32_16x16x32_bf16 a[108:111], a[196:199], v[168:171], 0
    s_waitcnt lgkmcnt(6)
    v_exp_f32 v173, v173
    v_mfma_f32_16x16x32_bf16 a[112:115], a[204:207], v[168:171], 0
    s_waitcnt lgkmcnt(4)
    v_exp_f32 v174, v174
    v_mfma_f32_16x16x32_bf16 a[116:119], a[200:203], v[168:171], 0
    s_waitcnt lgkmcnt(2)
    v_exp_f32 v175, v175
    v_mfma_f32_16x16x32_bf16 a[120:123], a[208:211], v[168:171], 0
    s_waitcnt lgkmcnt(0)
    v_exp_f32 v176, v176
    v_mfma_f32_16x16x32_bf16 a[124:127], a[216:219], v[168:171], 0
    buffer_load_dwordx4 v238, s[4:7], s30 offen offset:0 nt lds
    s_add_u32 m0, s34, 19456
    s_mov_b32 s30, 39168
    buffer_load_dwordx4 v239, s[4:7], s30 offen offset:0 nt lds
    v_exp_f32 v177, v177
    v_exp_f32 v178, v178
    v_exp_f32 v179, v179
    v_add_f32 v247, v172, v247
    v_add_f32 v247, v173, v247
    v_add_f32 v247, v174, v247
    v_add_f32 v247, v175, v247
    v_add_f32 v247, v176, v247
    v_add_f32 v247, v177, v247
    v_add_f32 v247, v178, v247
    v_add_f32 v247, v179, v247
    v_cvt_pk_bf16_f32 v172, v172, v173
    v_cvt_pk_bf16_f32 v173, v174, v175
    v_cvt_pk_bf16_f32 v174, v176, v177
    v_cvt_pk_bf16_f32 v175, v178, v179
    ds_read_b128 v[212:215], v250 offset:0
    ds_read_b128 v[220:223], v250 offset:2048
    ds_read_b128 v[224:227], v250 offset:256
    ds_read_b128 v[232:235], v250 offset:2304
    ds_read_b128 a[192:195], v250 offset:512
    ds_read_b128 a[200:203], v250 offset:2560
    ds_read_b128 a[204:207], v250 offset:768
    ds_read_b128 a[212:215], v250 offset:2816
    ds_read_b128 a[216:219], v250 offset:8192
    ds_read_b128 a[224:227], v250 offset:10240
    ds_read_b128 a[228:231], v250 offset:8448
    ds_read_b128 a[236:239], v250 offset:10496
    s_waitcnt vmcnt(12)
    s_waitcnt vmcnt(8)
    ds_read_b128 v[216:219], v253 offset:4096
    ds_read_b128 v[228:231], v253 offset:4352
    ds_read_b128 a[196:199], v253 offset:4608
    ds_read_b128 a[208:211], v253 offset:4864
    ds_read_b128 a[220:223], v253 offset:8192
    ds_read_b128 a[232:235], v253 offset:8448
    ds_read_b128 a[240:243], v250 offset:8704
    ds_read_b128 a[244:247], v253 offset:8704
    ds_read_b128 a[248:251], v250 offset:10752
    s_waitcnt lgkmcnt(8)
    v_mfma_f32_16x16x32_bf16 v[180:183], v[212:215], v[216:219], 0
    ds_read_b128 a[252:255], v250 offset:8960
    v_mfma_f32_16x16x32_bf16 v[188:191], v[220:223], v[216:219], 0
    s_waitcnt lgkmcnt(8)
    ds_read_b128 v[212:215], v253 offset:8960
    v_mfma_f32_16x16x32_bf16 v[180:183], v[224:227], v[228:231], v[180:183]
    ds_read_b128 v[220:223], v250 offset:11008
    s_mov_b32 m0, s35
    v_mfma_f32_16x16x32_bf16 v[188:191], v[232:235], v[228:231], v[188:191]
    s_waitcnt lgkmcnt(9)
    ds_read_b128 v[224:227], v250 offset:16384
    s_mov_b32 s30, 32768
    v_mfma_f32_16x16x32_bf16 v[180:183], a[192:195], a[196:199], v[180:183]
    ds_read_b128 v[232:235], v250 offset:18432
    buffer_load_dwordx4 v254, s[8:11], s30 offen offset:0 nt lds
    v_mfma_f32_16x16x32_bf16 v[188:191], a[200:203], a[196:199], v[188:191]
    s_waitcnt lgkmcnt(10)
    ds_read_b128 a[192:195], v250 offset:16640
    v_mfma_f32_16x16x32_bf16 v[180:183], a[204:207], a[208:211], v[180:183]
    ds_read_b128 a[200:203], v250 offset:18688
    v_mfma_f32_16x16x32_bf16 v[188:191], a[212:215], a[208:211], v[188:191]
    s_waitcnt lgkmcnt(11)
    ds_read_b128 a[204:207], v250 offset:16896
    v_mfma_f32_16x16x32_bf16 v[180:183], a[216:219], a[220:223], v[180:183]
    ds_read_b128 a[212:215], v250 offset:18944
    v_mfma_f32_16x16x32_bf16 v[188:191], a[224:227], a[220:223], v[188:191]
    s_waitcnt lgkmcnt(12)
    ds_read_b128 a[216:219], v250 offset:17152
    v_mfma_f32_16x16x32_bf16 v[180:183], a[228:231], a[232:235], v[180:183]
    ds_read_b128 a[224:227], v250 offset:19200
    v_mfma_f32_16x16x32_bf16 v[188:191], a[236:239], a[232:235], v[188:191]
    s_waitcnt lgkmcnt(12)
    ds_read_b128 a[228:231], v250 offset:24576
    v_mfma_f32_16x16x32_bf16 v[180:183], a[240:243], a[244:247], v[180:183]
    s_waitcnt lgkmcnt(12)
    ds_read_b128 a[236:239], v250 offset:26624
    s_mov_b32 m0, s35
    v_mfma_f32_16x16x32_bf16 v[188:191], a[248:251], a[244:247], v[188:191]
    s_waitcnt lgkmcnt(11)
    ds_read_b128 a[240:243], v250 offset:24832
    s_mov_b32 s30, 32768
    v_mfma_f32_16x16x32_bf16 v[180:183], a[252:255], v[212:215], v[180:183]
    s_waitcnt lgkmcnt(11)
    ds_read_b128 a[248:251], v250 offset:26880
    buffer_load_dwordx4 v254, s[8:11], s30 offen offset:1024 nt lds
    v_mfma_f32_16x16x32_bf16 v[188:191], v[220:223], v[212:215], v[188:191]
    s_waitcnt lgkmcnt(11)
    ds_read_b128 a[252:255], v250 offset:25088
    v_mfma_f32_16x16x32_bf16 v[184:187], v[224:227], v[216:219], 0
    s_waitcnt lgkmcnt(11)
    ds_read_b128 v[220:223], v250 offset:27136
    v_mfma_f32_16x16x32_bf16 v[192:195], v[232:235], v[216:219], 0
    s_waitcnt lgkmcnt(11)
    ds_read_b128 v[224:227], v250 offset:25344
    v_max3_f32 v144, v180, v181, v182
    v_mfma_f32_16x16x32_bf16 v[184:187], a[192:195], v[228:231], v[184:187]
    s_waitcnt lgkmcnt(11)
    ds_read_b128 v[216:219], v250 offset:27392
    v_max3_f32 v144, v144, v183, v188
    v_mfma_f32_16x16x32_bf16 v[192:195], a[200:203], v[228:231], v[192:195]
    s_waitcnt lgkmcnt(11)
    ds_read_b64_tr_b16 v[232:233], v251 offset:32768
    v_max3_f32 v144, v144, v189, v190
    v_mfma_f32_16x16x32_bf16 v[184:187], a[204:207], a[196:199], v[184:187]
    s_waitcnt lgkmcnt(11)
    ds_read_b64_tr_b16 v[234:235], v251 offset:34816
    v_max_f32 v144, v144, v191
    v_mfma_f32_16x16x32_bf16 v[192:195], a[212:215], a[196:199], v[192:195]
    s_waitcnt lgkmcnt(11)
    ds_read_b64_tr_b16 a[192:193], v252 offset:32768
    v_mov_b32 v248, v144
    v_mfma_f32_16x16x32_bf16 v[184:187], a[216:219], a[208:211], v[184:187]
    s_waitcnt lgkmcnt(11)
    ds_read_b64_tr_b16 a[194:195], v252 offset:34816
    v_permlane32_swap_b32 v144, v248
    v_mfma_f32_16x16x32_bf16 v[192:195], a[224:227], a[208:211], v[192:195]
    s_waitcnt lgkmcnt(11)
    ds_read_b64_tr_b16 v[228:229], v251 offset:33024
    s_mov_b32 m0, s35
    v_mfma_f32_16x16x32_bf16 v[184:187], a[228:231], a[220:223], v[184:187]
    s_waitcnt lgkmcnt(11)
    ds_read_b64_tr_b16 v[230:231], v251 offset:35072
    s_mov_b32 s30, 32768
    v_mfma_f32_16x16x32_bf16 v[192:195], a[236:239], a[220:223], v[192:195]
    s_waitcnt lgkmcnt(11)
    ds_read_b64_tr_b16 a[200:201], v252 offset:33024
    v_max_f32 v144, v144, v248
    v_mfma_f32_16x16x32_bf16 v[184:187], a[240:243], a[232:235], v[184:187]
    s_waitcnt lgkmcnt(11)
    ds_read_b64_tr_b16 a[202:203], v252 offset:35072
    v_mov_b32 v248, v144
    v_mfma_f32_16x16x32_bf16 v[192:195], a[248:251], a[232:235], v[192:195]
    s_waitcnt lgkmcnt(11)
    ds_read_b64_tr_b16 a[204:205], v251 offset:33280
    v_permlane16_swap_b32 v144, v248
    v_mfma_f32_16x16x32_bf16 v[184:187], a[252:255], a[244:247], v[184:187]
    s_waitcnt lgkmcnt(11)
    ds_read_b64_tr_b16 a[206:207], v251 offset:35328
    v_max_f32 v144, v144, v248
    v_mfma_f32_16x16x32_bf16 v[192:195], v[220:223], a[244:247], v[192:195]
    s_waitcnt lgkmcnt(11)
    ds_read_b64_tr_b16 a[196:197], v252 offset:33280
    v_mul_f32_e64 v144, -v144, s26
    v_mfma_f32_16x16x32_bf16 v[184:187], v[224:227], v[212:215], v[184:187]
    s_waitcnt lgkmcnt(11)
    ds_read_b64_tr_b16 a[198:199], v252 offset:35328
    v_cndmask_b32 v243, v144, v243, s[42:43]
    v_mfma_f32_16x16x32_bf16 v[192:195], v[216:219], v[212:215], v[192:195]
    ds_read_b64_tr_b16 a[212:213], v251 offset:33536
    buffer_load_dwordx4 v254, s[8:11], s30 offen offset:2048 nt lds
    ds_read_b64_tr_b16 a[214:215], v251 offset:35584
    ds_read_b64_tr_b16 a[216:217], v252 offset:33536
    ds_read_b64_tr_b16 a[218:219], v252 offset:35584
    ds_read_b64_tr_b16 a[208:209], v251 offset:40960
    ds_read_b64_tr_b16 a[210:211], v251 offset:43008
    ds_read_b64_tr_b16 a[224:225], v252 offset:40960
    ds_read_b64_tr_b16 a[226:227], v252 offset:43008
    ds_read_b64_tr_b16 a[228:229], v251 offset:41216
    ds_read_b64_tr_b16 a[230:231], v251 offset:43264
    ds_read_b64_tr_b16 a[220:221], v252 offset:41216
    ds_read_b64_tr_b16 a[222:223], v252 offset:43264
    v_mov_b32 v248, 0
    v_fma_f32 v180, v180, s26, v243
    v_fma_f32 v181, v181, s26, v243
    v_fma_f32 v182, v182, s26, v243
    v_fma_f32 v183, v183, s26, v243
    v_fma_f32 v188, v188, s26, v243
    v_fma_f32 v189, v189, s26, v243
    v_fma_f32 v190, v190, s26, v243
    v_fma_f32 v191, v191, s26, v243
    v_exp_f32 v180, v180
    v_exp_f32 v181, v181
    v_exp_f32 v182, v182
    v_exp_f32 v183, v183
    v_exp_f32 v188, v188
    v_exp_f32 v189, v189
    v_exp_f32 v190, v190
    v_exp_f32 v191, v191
    v_add_f32 v248, v180, v248
    v_add_f32 v248, v181, v248
    v_add_f32 v248, v182, v248
    v_add_f32 v248, v183, v248
    v_cvt_pk_bf16_f32 v180, v180, v181
    v_cvt_pk_bf16_f32 v181, v182, v183
    v_cvt_pk_bf16_f32 v182, v188, v189
    v_cvt_pk_bf16_f32 v183, v190, v191
    v_add_f32 v248, v188, v248
    v_add_f32 v248, v189, v248
    s_waitcnt lgkmcnt(15)
    v_mfma_f32_16x16x32_bf16 a[128:131], v[232:235], v[180:183], 0
    ds_read_b64_tr_b16 a[236:237], v251 offset:41472
    v_add_f32 v248, v190, v248
    v_mfma_f32_16x16x32_bf16 a[132:135], a[192:195], v[180:183], 0
    ds_read_b64_tr_b16 a[238:239], v251 offset:43520
    s_mov_b32 m0, s35
    v_mfma_f32_16x16x32_bf16 a[136:139], v[228:231], v[180:183], 0
    ds_read_b64_tr_b16 a[240:241], v252 offset:41472
    s_mov_b32 s30, 32768
    v_mfma_f32_16x16x32_bf16 a[140:143], a[200:203], v[180:183], 0
    s_waitcnt lgkmcnt(15)
    ds_read_b64_tr_b16 a[242:243], v252 offset:43520
    v_add_f32 v248, v191, v248
    v_mfma_f32_16x16x32_bf16 a[144:147], a[204:207], v[180:183], 0
    ds_read_b64_tr_b16 a[232:233], v251 offset:41728
    v_fma_f32 v184, v184, s26, v243
    v_mfma_f32_16x16x32_bf16 a[148:151], a[196:199], v[180:183], 0
    s_waitcnt lgkmcnt(15)
    ds_read_b64_tr_b16 a[234:235], v251 offset:43776
    v_fma_f32 v185, v185, s26, v243
    v_mfma_f32_16x16x32_bf16 a[152:155], a[212:215], v[180:183], 0
    s_waitcnt lgkmcnt(14)
    ds_read_b64_tr_b16 a[248:249], v252 offset:41728
    v_fma_f32 v186, v186, s26, v243
    v_mfma_f32_16x16x32_bf16 a[156:159], a[216:219], v[180:183], 0
    s_waitcnt lgkmcnt(13)
    ds_read_b64_tr_b16 a[250:251], v252 offset:43776
    v_fma_f32 v187, v187, s26, v243
    v_mfma_f32_16x16x32_bf16 a[160:163], a[208:211], v[180:183], 0
    s_waitcnt lgkmcnt(12)
    v_fma_f32 v192, v192, s26, v243
    v_fma_f32 v193, v193, s26, v243
    v_mfma_f32_16x16x32_bf16 a[164:167], a[224:227], v[180:183], 0
    s_waitcnt lgkmcnt(10)
    v_fma_f32 v194, v194, s26, v243
    v_fma_f32 v195, v195, s26, v243
    v_mfma_f32_16x16x32_bf16 a[168:171], a[228:231], v[180:183], 0
    s_waitcnt lgkmcnt(8)
    v_exp_f32 v184, v184
    v_mfma_f32_16x16x32_bf16 a[172:175], a[220:223], v[180:183], 0
    s_waitcnt lgkmcnt(6)
    v_exp_f32 v185, v185
    v_mfma_f32_16x16x32_bf16 a[176:179], a[236:239], v[180:183], 0
    s_waitcnt lgkmcnt(4)
    v_exp_f32 v186, v186
    v_mfma_f32_16x16x32_bf16 a[180:183], a[240:243], v[180:183], 0
    s_waitcnt lgkmcnt(2)
    v_exp_f32 v187, v187
    v_mfma_f32_16x16x32_bf16 a[184:187], a[232:235], v[180:183], 0
    s_waitcnt lgkmcnt(0)
    v_exp_f32 v192, v192
    v_mfma_f32_16x16x32_bf16 a[188:191], a[248:251], v[180:183], 0
    buffer_load_dwordx4 v254, s[8:11], s30 offen offset:3072 nt lds
    v_exp_f32 v193, v193
    v_exp_f32 v194, v194
    v_exp_f32 v195, v195
    v_add_f32 v248, v184, v248
    v_add_f32 v248, v185, v248
    v_add_f32 v248, v186, v248
    v_add_f32 v248, v187, v248
    v_add_f32 v248, v192, v248
    v_add_f32 v248, v193, v248
    v_add_f32 v248, v194, v248
    v_add_f32 v248, v195, v248
    v_cvt_pk_bf16_f32 v184, v184, v185
    v_cvt_pk_bf16_f32 v185, v186, v187
    v_cvt_pk_bf16_f32 v186, v192, v193
    v_cvt_pk_bf16_f32 v187, v194, v195
    ds_read_b128 v[212:215], v250 offset:0
    ds_read_b128 v[220:223], v250 offset:2048
    ds_read_b128 v[224:227], v250 offset:256
    ds_read_b128 v[232:235], v250 offset:2304
    ds_read_b128 a[192:195], v250 offset:512
    ds_read_b128 a[200:203], v250 offset:2560
    ds_read_b128 a[204:207], v250 offset:768
    ds_read_b128 a[212:215], v250 offset:2816
    ds_read_b128 a[216:219], v250 offset:8192
    ds_read_b128 a[224:227], v250 offset:10240
    ds_read_b128 a[228:231], v250 offset:8448
    ds_read_b128 a[236:239], v250 offset:10496
    s_waitcnt vmcnt(8)
    s_waitcnt vmcnt(4)
    ds_read_b128 v[216:219], v253 offset:12288
    ds_read_b128 v[228:231], v253 offset:12544
    ds_read_b128 a[196:199], v253 offset:12800
    ds_read_b128 a[208:211], v253 offset:13056
    ds_read_b128 a[220:223], v253 offset:16384
    ds_read_b128 a[232:235], v253 offset:16640
    ds_read_b128 a[240:243], v250 offset:8704
    ds_read_b128 a[244:247], v253 offset:16896
    ds_read_b128 a[248:251], v250 offset:10752
    s_waitcnt lgkmcnt(8)
    v_mfma_f32_16x16x32_bf16 v[196:199], v[212:215], v[216:219], 0
    ds_read_b128 a[252:255], v250 offset:8960
    v_mfma_f32_16x16x32_bf16 v[204:207], v[220:223], v[216:219], 0
    s_waitcnt lgkmcnt(8)
    ds_read_b128 v[156:159], v253 offset:17152
    v_mfma_f32_16x16x32_bf16 v[196:199], v[224:227], v[228:231], v[196:199]
    ds_read_b128 v[168:171], v250 offset:11008
    s_mov_b32 m0, s25
    v_mfma_f32_16x16x32_bf16 v[204:207], v[232:235], v[228:231], v[204:207]
    s_waitcnt lgkmcnt(9)
    ds_read_b128 v[180:183], v250 offset:16384
    s_mov_b32 s30, 16384
    v_mfma_f32_16x16x32_bf16 v[196:199], a[192:195], a[196:199], v[196:199]
    ds_read_b128 v[212:215], v250 offset:18432
    buffer_load_dwordx4 v254, s[12:15], s30 offen offset:0 nt lds
    v_mfma_f32_16x16x32_bf16 v[204:207], a[200:203], a[196:199], v[204:207]
    s_waitcnt lgkmcnt(10)
    ds_read_b128 v[220:223], v250 offset:16640
    v_mfma_f32_16x16x32_bf16 v[196:199], a[204:207], a[208:211], v[196:199]
    ds_read_b128 v[224:227], v250 offset:18688
    v_mfma_f32_16x16x32_bf16 v[204:207], a[212:215], a[208:211], v[204:207]
    s_waitcnt lgkmcnt(11)
    ds_read_b128 v[232:235], v250 offset:16896
    v_mfma_f32_16x16x32_bf16 v[196:199], a[216:219], a[220:223], v[196:199]
    ds_read_b128 a[192:195], v250 offset:18944
    v_mfma_f32_16x16x32_bf16 v[204:207], a[224:227], a[220:223], v[204:207]
    s_waitcnt lgkmcnt(12)
    ds_read_b128 a[200:203], v250 offset:17152
    v_mfma_f32_16x16x32_bf16 v[196:199], a[228:231], a[232:235], v[196:199]
    ds_read_b128 a[204:207], v250 offset:19200
    v_mfma_f32_16x16x32_bf16 v[204:207], a[236:239], a[232:235], v[204:207]
    s_waitcnt lgkmcnt(12)
    ds_read_b128 a[212:215], v250 offset:24576
    v_mfma_f32_16x16x32_bf16 v[196:199], a[240:243], a[244:247], v[196:199]
    s_waitcnt lgkmcnt(12)
    ds_read_b128 a[216:219], v250 offset:26624
    s_mov_b32 m0, s25
    v_mfma_f32_16x16x32_bf16 v[204:207], a[248:251], a[244:247], v[204:207]
    s_waitcnt lgkmcnt(11)
    ds_read_b128 a[224:227], v250 offset:24832
    s_mov_b32 s30, 16384
    v_mfma_f32_16x16x32_bf16 v[196:199], a[252:255], v[156:159], v[196:199]
    s_waitcnt lgkmcnt(11)
    ds_read_b128 a[228:231], v250 offset:26880
    buffer_load_dwordx4 v254, s[12:15], s30 offen offset:1024 nt lds
    v_mfma_f32_16x16x32_bf16 v[204:207], v[168:171], v[156:159], v[204:207]
    s_waitcnt lgkmcnt(11)
    ds_read_b128 a[236:239], v250 offset:25088
    v_mfma_f32_16x16x32_bf16 v[200:203], v[180:183], v[216:219], 0
    s_waitcnt lgkmcnt(11)
    ds_read_b128 a[240:243], v250 offset:27136
    v_mfma_f32_16x16x32_bf16 v[208:211], v[212:215], v[216:219], 0
    s_waitcnt lgkmcnt(11)
    ds_read_b128 a[248:251], v250 offset:25344
    v_max3_f32 v144, v196, v197, v198
    v_mfma_f32_16x16x32_bf16 v[200:203], v[220:223], v[228:231], v[200:203]
    s_waitcnt lgkmcnt(11)
    ds_read_b128 a[252:255], v250 offset:27392
    v_max3_f32 v144, v144, v199, v204
    v_mfma_f32_16x16x32_bf16 v[208:211], v[224:227], v[228:231], v[208:211]
    s_waitcnt lgkmcnt(11)
    ds_read_b64_tr_b16 v[168:169], v251 offset:32768
    v_max3_f32 v144, v144, v205, v206
    v_mfma_f32_16x16x32_bf16 v[200:203], v[232:235], a[196:199], v[200:203]
    s_waitcnt lgkmcnt(11)
    ds_read_b64_tr_b16 v[170:171], v251 offset:34816
    v_max_f32 v144, v144, v207
    v_mfma_f32_16x16x32_bf16 v[208:211], a[192:195], a[196:199], v[208:211]
    s_waitcnt lgkmcnt(11)
    ds_read_b64_tr_b16 v[180:181], v252 offset:32768
    v_mov_b32 v249, v144
    v_mfma_f32_16x16x32_bf16 v[200:203], a[200:203], a[208:211], v[200:203]
    s_waitcnt lgkmcnt(11)
    ds_read_b64_tr_b16 v[182:183], v252 offset:34816
    v_permlane32_swap_b32 v144, v249
    v_mfma_f32_16x16x32_bf16 v[208:211], a[204:207], a[208:211], v[208:211]
    s_waitcnt lgkmcnt(11)
    ds_read_b64_tr_b16 v[212:213], v251 offset:33024
    s_mov_b32 m0, s25
    v_mfma_f32_16x16x32_bf16 v[200:203], a[212:215], a[220:223], v[200:203]
    s_waitcnt lgkmcnt(11)
    ds_read_b64_tr_b16 v[214:215], v251 offset:35072
    s_mov_b32 s30, 16384
    v_mfma_f32_16x16x32_bf16 v[208:211], a[216:219], a[220:223], v[208:211]
    s_waitcnt lgkmcnt(11)
    ds_read_b64_tr_b16 v[216:217], v252 offset:33024
    v_max_f32 v144, v144, v249
    v_mfma_f32_16x16x32_bf16 v[200:203], a[224:227], a[232:235], v[200:203]
    s_waitcnt lgkmcnt(11)
    ds_read_b64_tr_b16 v[218:219], v252 offset:35072
    v_mov_b32 v249, v144
    v_mfma_f32_16x16x32_bf16 v[208:211], a[228:231], a[232:235], v[208:211]
    s_waitcnt lgkmcnt(11)
    ds_read_b64_tr_b16 v[220:221], v251 offset:33280
    v_permlane16_swap_b32 v144, v249
    v_mfma_f32_16x16x32_bf16 v[200:203], a[236:239], a[244:247], v[200:203]
    s_waitcnt lgkmcnt(11)
    ds_read_b64_tr_b16 v[222:223], v251 offset:35328
    v_max_f32 v144, v144, v249
    v_mfma_f32_16x16x32_bf16 v[208:211], a[240:243], a[244:247], v[208:211]
    s_waitcnt lgkmcnt(11)
    ds_read_b64_tr_b16 v[224:225], v252 offset:33280
    v_mul_f32_e64 v144, -v144, s26
    v_mfma_f32_16x16x32_bf16 v[200:203], a[248:251], v[156:159], v[200:203]
    s_waitcnt lgkmcnt(11)
    ds_read_b64_tr_b16 v[226:227], v252 offset:35328
    v_cndmask_b32 v244, v144, v244, s[42:43]
    v_mfma_f32_16x16x32_bf16 v[208:211], a[252:255], v[156:159], v[208:211]
    ds_read_b64_tr_b16 v[228:229], v251 offset:33536
    buffer_load_dwordx4 v254, s[12:15], s30 offen offset:2048 nt lds
    ds_read_b64_tr_b16 v[230:231], v251 offset:35584
    ds_read_b64_tr_b16 v[232:233], v252 offset:33536
    ds_read_b64_tr_b16 v[234:235], v252 offset:35584
    ds_read_b64_tr_b16 v[156:157], v251 offset:40960
    ds_read_b64_tr_b16 v[158:159], v251 offset:43008
    v_min_f32 v244, s101, v244
    v_mov_b32 v249, 0
    v_fma_f32 v196, v196, s26, v244
    v_fma_f32 v197, v197, s26, v244
    v_fma_f32 v198, v198, s26, v244
    v_fma_f32 v199, v199, s26, v244
    v_fma_f32 v204, v204, s26, v244
    v_fma_f32 v205, v205, s26, v244
    v_fma_f32 v206, v206, s26, v244
    v_fma_f32 v207, v207, s26, v244
    v_exp_f32 v196, v196
    v_exp_f32 v197, v197
    v_exp_f32 v198, v198
    v_exp_f32 v199, v199
    v_exp_f32 v204, v204
    v_exp_f32 v205, v205
    v_exp_f32 v206, v206
    v_exp_f32 v207, v207
    v_add_f32 v249, v196, v249
    v_add_f32 v249, v197, v249
    v_add_f32 v249, v198, v249
    v_add_f32 v249, v199, v249
    v_cvt_pk_bf16_f32 v196, v196, v197
    v_cvt_pk_bf16_f32 v197, v198, v199
    v_cvt_pk_bf16_f32 v198, v204, v205
    v_cvt_pk_bf16_f32 v199, v206, v207
    v_add_f32 v249, v204, v249
    v_add_f32 v249, v205, v249
    s_waitcnt lgkmcnt(15)
    v_mfma_f32_16x16x32_bf16 a[192:195], v[168:171], v[196:199], 0
    s_waitcnt lgkmcnt(14)
    ds_read_b64_tr_b16 v[168:169], v252 offset:40960
    v_add_f32 v249, v206, v249
    v_mfma_f32_16x16x32_bf16 a[196:199], v[180:183], v[196:199], 0
    s_waitcnt lgkmcnt(13)
    ds_read_b64_tr_b16 v[170:171], v252 offset:43008
    s_mov_b32 m0, s25
    v_mfma_f32_16x16x32_bf16 a[200:203], v[212:215], v[196:199], 0
    s_waitcnt lgkmcnt(12)
    ds_read_b64_tr_b16 v[180:181], v251 offset:41216
    s_mov_b32 s30, 16384
    v_mfma_f32_16x16x32_bf16 a[204:207], v[216:219], v[196:199], 0
    s_waitcnt lgkmcnt(11)
    ds_read_b64_tr_b16 v[182:183], v251 offset:43264
    v_add_f32 v249, v207, v249
    v_mfma_f32_16x16x32_bf16 a[208:211], v[220:223], v[196:199], 0
    s_waitcnt lgkmcnt(10)
    ds_read_b64_tr_b16 v[212:213], v252 offset:41216
    v_fma_f32 v200, v200, s26, v244
    v_mfma_f32_16x16x32_bf16 a[212:215], v[224:227], v[196:199], 0
    s_waitcnt lgkmcnt(9)
    ds_read_b64_tr_b16 v[214:215], v252 offset:43264
    v_fma_f32 v201, v201, s26, v244
    v_mfma_f32_16x16x32_bf16 a[216:219], v[228:231], v[196:199], 0
    s_waitcnt lgkmcnt(8)
    ds_read_b64_tr_b16 v[216:217], v251 offset:41472
    ds_read_b64_tr_b16 v[218:219], v251 offset:43520
    v_mfma_f32_16x16x32_bf16 a[220:223], v[232:235], v[196:199], 0
    s_waitcnt lgkmcnt(8)
    ds_read_b64_tr_b16 v[220:221], v252 offset:41472
    ds_read_b64_tr_b16 v[222:223], v252 offset:43520
    v_mfma_f32_16x16x32_bf16 a[224:227], v[156:159], v[196:199], 0
    s_waitcnt lgkmcnt(8)
    ds_read_b64_tr_b16 v[224:225], v251 offset:41728
    ds_read_b64_tr_b16 v[226:227], v251 offset:43776
    v_mfma_f32_16x16x32_bf16 a[228:231], v[168:171], v[196:199], 0
    s_waitcnt lgkmcnt(8)
    ds_read_b64_tr_b16 v[228:229], v252 offset:41728
    buffer_load_dwordx4 v254, s[12:15], s30 offen offset:3072 nt lds
    v_mfma_f32_16x16x32_bf16 a[232:235], v[180:183], v[196:199], 0
    s_waitcnt lgkmcnt(7)
    ds_read_b64_tr_b16 v[230:231], v252 offset:43776
    v_mfma_f32_16x16x32_bf16 a[236:239], v[212:215], v[196:199], 0
    s_waitcnt lgkmcnt(6)
    v_mfma_f32_16x16x32_bf16 a[240:243], v[216:219], v[196:199], 0
    s_waitcnt lgkmcnt(4)
    v_mfma_f32_16x16x32_bf16 a[244:247], v[220:223], v[196:199], 0
    s_waitcnt lgkmcnt(2)
    v_mfma_f32_16x16x32_bf16 a[248:251], v[224:227], v[196:199], 0
    s_waitcnt lgkmcnt(0)
    v_mfma_f32_16x16x32_bf16 a[252:255], v[228:231], v[196:199], 0
    s_mov_b32 s20, 49152
    s_mov_b32 s21, 32768
    s_mov_b32 s27, 14
    s_mov_b32 s94, 0
    s_and_b32 s30, s29, 1
    s_lshl_b32 s30, s30, 13
    s_lshr_b32 s31, s29, 1
    s_lshl_b32 s31, s31, 14
    s_sub_u32 s30, s30, s31
    s_add_u32 s30, s30, 49152
    v_lshlrev_b32 v236, 7, v255
    v_add_u32 v236, s30, v236
    v_subrev_u32 v236, 16384, v236
    s_waitcnt lgkmcnt(0)
    s_waitcnt vmcnt(4)
    s_barrier
    ds_read_b128 v[212:215], v250 offset:34816
    ds_read_b128 v[216:219], v250 offset:35072
    ds_read_b128 v[220:223], v253 offset:4096
    ds_read_b128 v[224:227], v253 offset:4352
    s_waitcnt lgkmcnt(0)
    v_mfma_f32_16x16x32_bf16 v[152:155], v[212:215], v[64:67], 0
    ds_read_b128 v[228:231], v250 offset:33024
    v_fma_f32 v202, v202, s26, v244
    v_mfma_f32_16x16x32_bf16 v[152:155], v[216:219], v[68:71], v[152:155]
    ds_read_b128 v[232:235], v250 offset:32768
    v_mfma_f32_16x16x32_bf16 v[164:167], v[216:219], v[100:103], 0
    s_mov_b32 m0, s23
    v_mfma_f32_16x16x32_bf16 v[164:167], v[212:215], v[96:99], v[164:167]
    buffer_load_dwordx4 v254, s[8:11], s20 offen offset:0 nt lds
    v_mfma_f32_16x16x32_bf16 v[188:191], v[212:215], v[220:223], 0
    v_exp_f32 v200, v200
    v_mfma_f32_16x16x32_bf16 v[188:191], v[216:219], v[224:227], v[188:191]
    s_waitcnt lgkmcnt(1)
    v_exp_f32 v201, v201
    v_mfma_f32_16x16x32_bf16 v[180:183], v[228:231], v[224:227], 0
    s_waitcnt lgkmcnt(0)
    ds_read_b128 v[144:147], v253 offset:12288
    v_mfma_f32_16x16x32_bf16 v[180:183], v[232:235], v[220:223], v[180:183]
    ds_read_b128 v[156:159], v253 offset:12544
    v_mfma_f32_16x16x32_bf16 v[168:171], v[232:235], v[128:131], 0
    v_exp_f32 v202, v202
    v_mfma_f32_16x16x32_bf16 v[168:171], v[228:231], v[132:135], v[168:171]
    buffer_load_dwordx4 v254, s[8:11], s20 offen offset:1024 nt lds
    v_mfma_f32_16x16x32_bf16 v[176:179], v[216:219], v[132:135], 0
    v_add_f32 v249, v200, v249
    v_cvt_pk_bf16_f32 v200, v200, v201
    v_mfma_f32_16x16x32_bf16 v[176:179], v[212:215], v[128:131], v[176:179]
    s_waitcnt lgkmcnt(1)
    v_add_f32 v249, v201, v249
    v_add_f32 v249, v202, v249
    v_mfma_f32_16x16x32_bf16 v[204:207], v[212:215], v[144:147], 0
    s_waitcnt lgkmcnt(0)
    v_fma_f32 v203, v203, s26, v244
    v_fma_f32 v208, v208, s26, v244
    v_mfma_f32_16x16x32_bf16 v[204:207], v[216:219], v[156:159], v[204:207]
    buffer_load_dwordx4 v254, s[8:11], s20 offen offset:2048 nt lds
    v_mfma_f32_16x16x32_bf16 v[196:199], v[228:231], v[156:159], 0
    ds_read_b128 v[192:195], v250 offset:33280
    v_fma_f32 v209, v209, s26, v244
    v_mfma_f32_16x16x32_bf16 v[196:199], v[232:235], v[144:147], v[196:199]
    ds_read_b128 v[224:227], v250 offset:33536
    v_fma_f32 v210, v210, s26, v244
    v_mfma_f32_16x16x32_bf16 v[156:159], v[232:235], v[96:99], 0
    v_exp_f32 v203, v203
    v_mfma_f32_16x16x32_bf16 v[156:159], v[228:231], v[100:103], v[156:159]
    ds_read_b128 v[220:223], v253 offset:4864
    v_fma_f32 v211, v211, s26, v244
    v_mfma_f32_16x16x32_bf16 v[144:147], v[228:231], v[68:71], 0
    ds_read_b128 v[212:215], v253 offset:4608
    v_cvt_pk_bf16_f32 v201, v202, v203
    v_mfma_f32_16x16x32_bf16 v[144:147], v[232:235], v[64:67], v[144:147]
    s_waitcnt lgkmcnt(3)
    buffer_load_dwordx4 v254, s[8:11], s20 offen offset:3072 nt lds
    v_mfma_f32_16x16x32_bf16 v[144:147], v[192:195], v[72:75], v[144:147]
    s_waitcnt lgkmcnt(2)
    ds_read_b128 v[216:219], v250 offset:35584
    v_add_f32 v249, v203, v249
    v_mfma_f32_16x16x32_bf16 v[144:147], v[224:227], v[76:79], v[144:147]
    s_add_u32 s20, s20, 16384
    ds_read_b128 v[228:231], v250 offset:35328
    v_mfma_f32_16x16x32_bf16 v[156:159], v[224:227], v[108:111], v[156:159]
    v_exp_f32 v208, v208
    v_mfma_f32_16x16x32_bf16 v[156:159], v[192:195], v[104:107], v[156:159]
    s_waitcnt lgkmcnt(2)
    v_exp_f32 v209, v209
    v_mfma_f32_16x16x32_bf16 v[180:183], v[192:195], v[212:215], v[180:183]
    s_waitcnt lgkmcnt(3)
    v_exp_f32 v210, v210
    v_mfma_f32_16x16x32_bf16 v[180:183], v[224:227], v[220:223], v[180:183]
    s_waitcnt lgkmcnt(1)
    v_exp_f32 v211, v211
    v_mfma_f32_16x16x32_bf16 v[188:191], v[216:219], v[220:223], v[188:191]
    s_waitcnt lgkmcnt(0)
    ds_read_b128 v[232:235], v253 offset:12800
    v_cvt_pk_bf16_f32 v202, v208, v209
    v_mfma_f32_16x16x32_bf16 v[188:191], v[228:231], v[212:215], v[188:191]
    s_mov_b32 m0, s24
    ds_read_b128 v[220:223], v253 offset:13056
    v_cvt_pk_bf16_f32 v203, v210, v211
    v_mfma_f32_16x16x32_bf16 v[176:179], v[228:231], v[136:139], v[176:179]
    buffer_load_dwordx4 v254, s[12:15], s21 offen offset:0 nt lds
    v_mfma_f32_16x16x32_bf16 v[176:179], v[216:219], v[140:143], v[176:179]
    v_add_f32 v249, v208, v249
    v_add_f32 v249, v209, v249
    v_mfma_f32_16x16x32_bf16 v[168:171], v[224:227], v[140:143], v[168:171]
    v_add_f32 v249, v210, v249
    v_add_f32 v249, v211, v249
    v_mfma_f32_16x16x32_bf16 v[168:171], v[192:195], v[136:139], v[168:171]
    s_waitcnt lgkmcnt(1)
    v_mfma_f32_16x16x32_bf16 v[196:199], v[192:195], v[232:235], v[196:199]
    s_waitcnt lgkmcnt(0)
    v_mfma_f32_16x16x32_bf16 v[196:199], v[224:227], v[220:223], v[196:199]
    buffer_load_dwordx4 v254, s[12:15], s21 offen offset:1024 nt lds
    v_mfma_f32_16x16x32_bf16 v[204:207], v[216:219], v[220:223], v[204:207]
    ds_read_b128 v[208:211], v250 offset:43008
    v_mfma_f32_16x16x32_bf16 v[204:207], v[228:231], v[232:235], v[204:207]
    ds_read_b128 v[192:195], v250 offset:43264
    v_mfma_f32_16x16x32_bf16 v[164:167], v[228:231], v[104:107], v[164:167]
    v_mfma_f32_16x16x32_bf16 v[164:167], v[216:219], v[108:111], v[164:167]
    ds_read_b128 v[212:215], v253 offset:256
    v_mfma_f32_16x16x32_bf16 v[152:155], v[216:219], v[76:79], v[152:155]
    ds_read_b128 v[224:227], v253 offset:0
    v_mfma_f32_16x16x32_bf16 v[152:155], v[228:231], v[72:75], v[152:155]
    s_waitcnt lgkmcnt(3)
    buffer_load_dwordx4 v254, s[12:15], s21 offen offset:2048 nt lds
    v_mfma_f32_16x16x32_bf16 v[152:155], v[208:211], v[80:83], v[152:155]
    s_waitcnt lgkmcnt(2)
    ds_read_b128 v[220:223], v250 offset:41216
    v_mfma_f32_16x16x32_bf16 v[152:155], v[192:195], v[84:87], v[152:155]
    ds_read_b128 v[232:235], v250 offset:40960
    v_mfma_f32_16x16x32_bf16 v[164:167], v[192:195], v[116:119], v[164:167]
    ds_read_b128 v[216:219], v253 offset:8192
    v_mfma_f32_16x16x32_bf16 v[164:167], v[208:211], v[112:115], v[164:167]
    s_waitcnt lgkmcnt(3)
    ds_read_b128 v[228:231], v253 offset:8448
    v_mfma_f32_16x16x32_bf16 v[176:179], v[208:211], v[224:227], v[176:179]
    s_waitcnt lgkmcnt(5)
    v_mfma_f32_16x16x32_bf16 v[176:179], v[192:195], v[212:215], v[176:179]
    s_waitcnt lgkmcnt(3)
    v_mfma_f32_16x16x32_bf16 v[168:171], v[220:223], v[212:215], v[168:171]
    s_waitcnt lgkmcnt(2)
    ds_read_b128 v[212:215], v253 offset:16384
    v_mfma_f32_16x16x32_bf16 v[168:171], v[232:235], v[224:227], v[168:171]
    s_waitcnt lgkmcnt(2)
    ds_read_b128 v[224:227], v253 offset:16640
    v_mfma_f32_16x16x32_bf16 v[180:183], v[232:235], v[216:219], v[180:183]
    s_waitcnt lgkmcnt(2)
    v_mfma_f32_16x16x32_bf16 v[180:183], v[220:223], v[228:231], v[180:183]
    v_mfma_f32_16x16x32_bf16 v[188:191], v[192:195], v[228:231], v[188:191]
    v_mfma_f32_16x16x32_bf16 v[188:191], v[208:211], v[216:219], v[188:191]
    s_waitcnt lgkmcnt(1)
    buffer_load_dwordx4 v254, s[12:15], s21 offen offset:3072 nt lds
    v_mfma_f32_16x16x32_bf16 v[204:207], v[208:211], v[212:215], v[204:207]
    s_waitcnt lgkmcnt(0)
    v_mfma_f32_16x16x32_bf16 v[204:207], v[192:195], v[224:227], v[204:207]
    s_add_u32 s21, s21, 16384
    v_mfma_f32_16x16x32_bf16 v[196:199], v[220:223], v[224:227], v[196:199]
    ds_read_b128 v[208:211], v250 offset:41472
    v_mfma_f32_16x16x32_bf16 v[196:199], v[232:235], v[212:215], v[196:199]
    ds_read_b128 v[192:195], v250 offset:41728
    v_mfma_f32_16x16x32_bf16 v[156:159], v[232:235], v[112:115], v[156:159]
    v_mfma_f32_16x16x32_bf16 v[156:159], v[220:223], v[116:119], v[156:159]
    v_mfma_f32_16x16x32_bf16 v[144:147], v[220:223], v[84:87], v[144:147]
    ds_read_b128 v[228:231], v253 offset:512
    v_mfma_f32_16x16x32_bf16 v[144:147], v[232:235], v[80:83], v[144:147]
    s_waitcnt lgkmcnt(2)
    ds_read_b128 v[216:219], v253 offset:768
    v_mfma_f32_16x16x32_bf16 v[144:147], v[208:211], v[88:91], v[144:147]
    s_waitcnt lgkmcnt(2)
    ds_read_b128 v[224:227], v250 offset:43776
    v_mfma_f32_16x16x32_bf16 v[144:147], v[192:195], v[92:95], v[144:147]
    ds_read_b128 v[212:215], v250 offset:43520
    v_mfma_f32_16x16x32_bf16 v[156:159], v[192:195], v[124:127], v[156:159]
    ds_read_b128 v[220:223], v253 offset:8704
    v_mfma_f32_16x16x32_bf16 v[156:159], v[208:211], v[120:123], v[156:159]
    s_waitcnt lgkmcnt(4)
    ds_read_b128 v[232:235], v253 offset:8960
    v_mfma_f32_16x16x32_bf16 v[168:171], v[208:211], v[228:231], v[168:171]
    s_waitcnt lgkmcnt(4)
    buffer_load_dword v237, v236, s[92:95], s20 offen offset:0
    v_mfma_f32_16x16x32_bf16 v[168:171], v[192:195], v[216:219], v[168:171]
    s_waitcnt lgkmcnt(3)
    v_mfma_f32_16x16x32_bf16 v[176:179], v[224:227], v[216:219], v[176:179]
    s_waitcnt lgkmcnt(2)
    ds_read_b128 v[216:219], v253 offset:16896
    v_mfma_f32_16x16x32_bf16 v[176:179], v[212:215], v[228:231], v[176:179]
    s_waitcnt lgkmcnt(2)
    ds_read_b128 v[228:231], v253 offset:17152
    v_mfma_f32_16x16x32_bf16 v[188:191], v[212:215], v[220:223], v[188:191]
    s_waitcnt lgkmcnt(2)
    v_mfma_f32_16x16x32_bf16 v[188:191], v[224:227], v[232:235], v[188:191]
    s_waitcnt vmcnt(9)
    s_barrier
    v_mfma_f32_16x16x32_bf16 v[180:183], v[192:195], v[232:235], v[180:183]
    v_fma_f32 v144, v144, s26, v240
    v_fma_f32 v145, v145, s26, v240
    v_mfma_f32_16x16x32_bf16 v[180:183], v[208:211], v[220:223], v[180:183]
    s_waitcnt lgkmcnt(1)
    v_exp_f32 v144, v144
    v_mfma_f32_16x16x32_bf16 v[196:199], v[208:211], v[216:219], v[196:199]
    s_waitcnt lgkmcnt(0)
    v_exp_f32 v145, v145
    v_mfma_f32_16x16x32_bf16 v[196:199], v[192:195], v[228:231], v[196:199]
    ds_read_b64_tr_b16 v[208:209], v251 offset:16384
    v_add_f32 v245, v144, v245
    v_mfma_f32_16x16x32_bf16 v[204:207], v[224:227], v[228:231], v[204:207]
    ds_read_b64_tr_b16 v[210:211], v251 offset:18432
    v_cvt_pk_bf16_f32 v144, v144, v145
    v_mfma_f32_16x16x32_bf16 v[204:207], v[212:215], v[216:219], v[204:207]
    v_add_f32 v245, v145, v245
    v_fma_f32 v146, v146, s26, v240
    v_mfma_f32_16x16x32_bf16 v[164:167], v[212:215], v[120:123], v[164:167]
    v_exp_f32 v146, v146
    v_mfma_f32_16x16x32_bf16 v[164:167], v[224:227], v[124:127], v[164:167]
    v_fma_f32 v147, v147, s26, v240
    v_fma_f32 v156, v156, s26, v241
    v_mfma_f32_16x16x32_bf16 v[152:155], v[224:227], v[92:95], v[152:155]
    ds_read_b64_tr_b16 v[192:193], v252 offset:16384
    v_add_f32 v245, v146, v245
    v_mfma_f32_16x16x32_bf16 v[152:155], v[212:215], v[88:91], v[152:155]
    s_waitcnt lgkmcnt(1)
    ds_read_b64_tr_b16 v[194:195], v252 offset:18432
    v_fma_f32 v157, v157, s26, v241
    v_mfma_f32_16x16x32_bf16 v[0:3], v[208:211], v[148:151], v[0:3]
    v_exp_f32 v147, v147
    v_mfma_f32_16x16x32_bf16 a[0:3], v[208:211], v[160:163], a[0:3]
    v_exp_f32 v156, v156
    v_mfma_f32_16x16x32_bf16 a[64:67], v[208:211], v[172:175], a[64:67]
    v_exp_f32 v157, v157
    v_mfma_f32_16x16x32_bf16 a[128:131], v[208:211], v[184:187], a[128:131]
    ds_read_b64_tr_b16 v[232:233], v251 offset:16640
    v_cvt_pk_bf16_f32 v145, v146, v147
    v_mfma_f32_16x16x32_bf16 a[192:195], v[208:211], v[200:203], a[192:195]
    s_waitcnt lgkmcnt(1)
    ds_read_b64_tr_b16 v[234:235], v251 offset:18688
    v_add_f32 v245, v147, v245
    v_mfma_f32_16x16x32_bf16 a[196:199], v[192:195], v[200:203], a[196:199]
    v_fma_f32 v152, v152, s26, v240
    v_fma_f32 v153, v153, s26, v240
    v_mfma_f32_16x16x32_bf16 a[132:135], v[192:195], v[184:187], a[132:135]
    v_exp_f32 v152, v152
    v_mfma_f32_16x16x32_bf16 a[68:71], v[192:195], v[172:175], a[68:71]
    v_exp_f32 v153, v153
    v_mfma_f32_16x16x32_bf16 a[4:7], v[192:195], v[160:163], a[4:7]
    ds_read_b64_tr_b16 v[208:209], v252 offset:16640
    v_add_f32 v245, v152, v245
    v_mfma_f32_16x16x32_bf16 v[4:7], v[192:195], v[148:151], v[4:7]
    s_waitcnt lgkmcnt(1)
    ds_read_b64_tr_b16 v[210:211], v252 offset:18688
    v_cvt_pk_bf16_f32 v146, v152, v153
    v_mfma_f32_16x16x32_bf16 v[8:11], v[232:235], v[148:151], v[8:11]
    v_add_f32 v245, v153, v245
    v_fma_f32 v154, v154, s26, v240
    v_mfma_f32_16x16x32_bf16 a[8:11], v[232:235], v[160:163], a[8:11]
    v_exp_f32 v154, v154
    v_mfma_f32_16x16x32_bf16 a[72:75], v[232:235], v[172:175], a[72:75]
    v_fma_f32 v155, v155, s26, v240
    v_add_f32 v246, v156, v246
    v_mfma_f32_16x16x32_bf16 a[136:139], v[232:235], v[184:187], a[136:139]
    ds_read_b64_tr_b16 v[192:193], v251 offset:16896
    v_add_f32 v245, v154, v245
    v_mfma_f32_16x16x32_bf16 a[200:203], v[232:235], v[200:203], a[200:203]
    s_waitcnt lgkmcnt(1)
    ds_read_b64_tr_b16 v[194:195], v251 offset:18944
    v_cvt_pk_bf16_f32 v156, v156, v157
    v_mfma_f32_16x16x32_bf16 a[204:207], v[208:211], v[200:203], a[204:207]
    v_exp_f32 v155, v155
    v_mfma_f32_16x16x32_bf16 a[140:143], v[208:211], v[184:187], a[140:143]
    v_add_f32 v246, v157, v246
    v_fma_f32 v158, v158, s26, v241
    v_mfma_f32_16x16x32_bf16 a[76:79], v[208:211], v[172:175], a[76:79]
    v_exp_f32 v158, v158
    v_mfma_f32_16x16x32_bf16 a[12:15], v[208:211], v[160:163], a[12:15]
    ds_read_b64_tr_b16 v[220:221], v252 offset:16896
    v_cvt_pk_bf16_f32 v147, v154, v155
    v_mfma_f32_16x16x32_bf16 v[12:15], v[208:211], v[148:151], v[12:15]
    s_waitcnt lgkmcnt(1)
    ds_read_b64_tr_b16 v[222:223], v252 offset:18944
    v_add_f32 v245, v155, v245
    v_mfma_f32_16x16x32_bf16 v[16:19], v[192:195], v[148:151], v[16:19]
    v_add_f32 v246, v158, v246
    v_fma_f32 v159, v159, s26, v241
    v_mfma_f32_16x16x32_bf16 a[16:19], v[192:195], v[160:163], a[16:19]
    v_exp_f32 v159, v159
    v_mfma_f32_16x16x32_bf16 a[80:83], v[192:195], v[172:175], a[80:83]
    v_fma_f32 v164, v164, s26, v241
    v_fma_f32 v165, v165, s26, v241
    v_mfma_f32_16x16x32_bf16 a[144:147], v[192:195], v[184:187], a[144:147]
    ds_read_b64_tr_b16 v[208:209], v251 offset:17152
    v_cvt_pk_bf16_f32 v157, v158, v159
    v_mfma_f32_16x16x32_bf16 a[208:211], v[192:195], v[200:203], a[208:211]
    s_waitcnt lgkmcnt(1)
    ds_read_b64_tr_b16 v[210:211], v251 offset:19200
    v_add_f32 v246, v159, v246
    v_mfma_f32_16x16x32_bf16 a[212:215], v[220:223], v[200:203], a[212:215]
    v_exp_f32 v164, v164
    v_mfma_f32_16x16x32_bf16 a[148:151], v[220:223], v[184:187], a[148:151]
    v_exp_f32 v165, v165
    v_mfma_f32_16x16x32_bf16 a[84:87], v[220:223], v[172:175], a[84:87]
    v_add_f32 v246, v164, v246
    v_fma_f32 v166, v166, s26, v241
    v_mfma_f32_16x16x32_bf16 a[20:23], v[220:223], v[160:163], a[20:23]
    ds_read_b64_tr_b16 v[192:193], v252 offset:17152
    v_cvt_pk_bf16_f32 v158, v164, v165
    v_mfma_f32_16x16x32_bf16 v[20:23], v[220:223], v[148:151], v[20:23]
    s_waitcnt lgkmcnt(1)
    ds_read_b64_tr_b16 v[194:195], v252 offset:19200
    v_add_f32 v246, v165, v246
    v_mfma_f32_16x16x32_bf16 v[24:27], v[208:211], v[148:151], v[24:27]
    v_exp_f32 v166, v166
    v_mfma_f32_16x16x32_bf16 a[24:27], v[208:211], v[160:163], a[24:27]
    v_fma_f32 v167, v167, s26, v241
    v_fma_f32 v168, v168, s26, v242
    v_mfma_f32_16x16x32_bf16 a[88:91], v[208:211], v[172:175], a[88:91]
    v_exp_f32 v167, v167
    v_mfma_f32_16x16x32_bf16 a[152:155], v[208:211], v[184:187], a[152:155]
    ds_read_b64_tr_b16 v[228:229], v251 offset:24576
    v_add_f32 v246, v166, v246
    v_mfma_f32_16x16x32_bf16 a[216:219], v[208:211], v[200:203], a[216:219]
    s_waitcnt lgkmcnt(1)
    ds_read_b64_tr_b16 v[230:231], v251 offset:26624
    v_cvt_pk_bf16_f32 v159, v166, v167
    v_mfma_f32_16x16x32_bf16 a[220:223], v[192:195], v[200:203], a[220:223]
    v_exp_f32 v168, v168
    v_mfma_f32_16x16x32_bf16 a[156:159], v[192:195], v[184:187], a[156:159]
    v_add_f32 v246, v167, v246
    v_fma_f32 v169, v169, s26, v242
    v_mfma_f32_16x16x32_bf16 a[92:95], v[192:195], v[172:175], a[92:95]
    v_exp_f32 v169, v169
    v_mfma_f32_16x16x32_bf16 a[28:31], v[192:195], v[160:163], a[28:31]
    ds_read_b64_tr_b16 v[208:209], v252 offset:24576
    v_add_f32 v247, v168, v247
    v_mfma_f32_16x16x32_bf16 v[28:31], v[192:195], v[148:151], v[28:31]
    s_waitcnt lgkmcnt(1)
    ds_read_b64_tr_b16 v[210:211], v252 offset:26624
    v_cvt_pk_bf16_f32 v168, v168, v169
    v_mfma_f32_16x16x32_bf16 v[32:35], v[228:231], v[148:151], v[32:35]
    v_add_f32 v247, v169, v247
    v_fma_f32 v170, v170, s26, v242
    v_mfma_f32_16x16x32_bf16 a[32:35], v[228:231], v[160:163], a[32:35]
    v_exp_f32 v170, v170
    v_mfma_f32_16x16x32_bf16 a[96:99], v[228:231], v[172:175], a[96:99]
    v_fma_f32 v171, v171, s26, v242
    v_fma_f32 v176, v176, s26, v242
    v_mfma_f32_16x16x32_bf16 a[160:163], v[228:231], v[184:187], a[160:163]
    ds_read_b64_tr_b16 v[192:193], v251 offset:24832
    v_add_f32 v247, v170, v247
    v_mfma_f32_16x16x32_bf16 a[224:227], v[228:231], v[200:203], a[224:227]
    s_waitcnt lgkmcnt(1)
    ds_read_b64_tr_b16 v[194:195], v251 offset:26880
    v_fma_f32 v177, v177, s26, v242
    v_mfma_f32_16x16x32_bf16 a[228:231], v[208:211], v[200:203], a[228:231]
    v_exp_f32 v171, v171
    v_mfma_f32_16x16x32_bf16 a[164:167], v[208:211], v[184:187], a[164:167]
    v_exp_f32 v176, v176
    v_mfma_f32_16x16x32_bf16 a[100:103], v[208:211], v[172:175], a[100:103]
    v_exp_f32 v177, v177
    v_mfma_f32_16x16x32_bf16 a[36:39], v[208:211], v[160:163], a[36:39]
    ds_read_b64_tr_b16 v[216:217], v252 offset:24832
    v_cvt_pk_bf16_f32 v169, v170, v171
    v_mfma_f32_16x16x32_bf16 v[36:39], v[208:211], v[148:151], v[36:39]
    s_waitcnt lgkmcnt(1)
    ds_read_b64_tr_b16 v[218:219], v252 offset:26880
    v_cvt_pk_bf16_f32 v170, v176, v177
    v_mfma_f32_16x16x32_bf16 v[40:43], v[192:195], v[148:151], v[40:43]
    v_add_f32 v247, v171, v247
    v_add_f32 v247, v176, v247
    v_mfma_f32_16x16x32_bf16 a[40:43], v[192:195], v[160:163], a[40:43]
    v_add_f32 v247, v177, v247
    v_fma_f32 v178, v178, s26, v242
    v_mfma_f32_16x16x32_bf16 a[104:107], v[192:195], v[172:175], a[104:107]
    v_exp_f32 v178, v178
    v_mfma_f32_16x16x32_bf16 a[168:171], v[192:195], v[184:187], a[168:171]
    ds_read_b64_tr_b16 v[208:209], v251 offset:25088
    v_fma_f32 v179, v179, s26, v242
    v_mfma_f32_16x16x32_bf16 a[232:235], v[192:195], v[200:203], a[232:235]
    s_waitcnt lgkmcnt(1)
    ds_read_b64_tr_b16 v[210:211], v251 offset:27136
    v_add_f32 v247, v178, v247
    v_mfma_f32_16x16x32_bf16 a[236:239], v[216:219], v[200:203], a[236:239]
    v_exp_f32 v179, v179
    v_mfma_f32_16x16x32_bf16 a[172:175], v[216:219], v[184:187], a[172:175]
    ds_read_b64_tr_b16 v[192:193], v252 offset:25088
    v_fma_f32 v180, v180, s26, v243
    v_mfma_f32_16x16x32_bf16 a[108:111], v[216:219], v[172:175], a[108:111]
    ds_read_b64_tr_b16 v[194:195], v252 offset:27136
    v_cvt_pk_bf16_f32 v171, v178, v179
    v_mfma_f32_16x16x32_bf16 a[44:47], v[216:219], v[160:163], a[44:47]
    ds_read_b64_tr_b16 v[224:225], v251 offset:25344
    v_add_f32 v247, v179, v247
    v_mfma_f32_16x16x32_bf16 v[44:47], v[216:219], v[148:151], v[44:47]
    s_waitcnt lgkmcnt(3)
    ds_read_b64_tr_b16 v[226:227], v251 offset:27392
    v_fma_f32 v181, v181, s26, v243
    v_mfma_f32_16x16x32_bf16 v[48:51], v[208:211], v[148:151], v[48:51]
    ds_read_b64_tr_b16 v[232:233], v252 offset:25344
    v_fma_f32 v182, v182, s26, v243
    v_mfma_f32_16x16x32_bf16 a[48:51], v[208:211], v[160:163], a[48:51]
    ds_read_b64_tr_b16 v[234:235], v252 offset:27392
    v_fma_f32 v183, v183, s26, v243
    v_mfma_f32_16x16x32_bf16 a[112:115], v[208:211], v[172:175], a[112:115]
    v_exp_f32 v180, v180
    v_mfma_f32_16x16x32_bf16 a[176:179], v[208:211], v[184:187], a[176:179]
    v_exp_f32 v181, v181
    v_mfma_f32_16x16x32_bf16 a[240:243], v[208:211], v[200:203], a[240:243]
    s_waitcnt lgkmcnt(4)
    v_exp_f32 v182, v182
    v_mfma_f32_16x16x32_bf16 a[244:247], v[192:195], v[200:203], a[244:247]
    v_exp_f32 v183, v183
    v_mfma_f32_16x16x32_bf16 a[180:183], v[192:195], v[184:187], a[180:183]
    s_waitcnt vmcnt(1) lgkmcnt(0)
    s_barrier
    v_mfma_f32_16x16x32_bf16 a[116:119], v[192:195], v[172:175], a[116:119]
    s_mov_b32 m0, s35
    s_mov_b32 s30, 507904
    v_add_f32 v248, v180, v248
    v_cvt_pk_bf16_f32 v180, v180, v181
    v_mfma_f32_16x16x32_bf16 a[52:55], v[192:195], v[160:163], a[52:55]
    buffer_load_dwordx4 v254, s[12:15], s30 offen offset:0 nt lds
    v_add_f32 v248, v181, v248
    v_cvt_pk_bf16_f32 v181, v182, v183
    v_mfma_f32_16x16x32_bf16 v[52:55], v[192:195], v[148:151], v[52:55]
    v_add_f32 v248, v182, v248
    v_add_f32 v248, v183, v248
    v_mfma_f32_16x16x32_bf16 v[56:59], v[224:227], v[148:151], v[56:59]
    buffer_load_dwordx4 v254, s[12:15], s30 offen offset:1024 nt lds
    v_fma_f32 v188, v188, s26, v243
    v_fma_f32 v189, v189, s26, v243
    v_mfma_f32_16x16x32_bf16 a[56:59], v[224:227], v[160:163], a[56:59]
    v_exp_f32 v188, v188
    v_mfma_f32_16x16x32_bf16 a[120:123], v[224:227], v[172:175], a[120:123]
    buffer_load_dwordx4 v254, s[12:15], s30 offen offset:2048 nt lds
    v_exp_f32 v189, v189
    v_mfma_f32_16x16x32_bf16 a[184:187], v[224:227], v[184:187], a[184:187]
    v_add_f32 v248, v188, v248
    v_fma_f32 v190, v190, s26, v243
    v_mfma_f32_16x16x32_bf16 a[248:251], v[224:227], v[200:203], a[248:251]
    ds_read_b128 v[212:215], v250 offset:18432
    v_cvt_pk_bf16_f32 v182, v188, v189
    v_mfma_f32_16x16x32_bf16 a[252:255], v[232:235], v[200:203], a[252:255]
    ds_read_b128 v[216:219], v250 offset:18688
    v_add_f32 v248, v189, v248
    v_mfma_f32_16x16x32_bf16 a[188:191], v[232:235], v[184:187], a[188:191]
    buffer_load_dwordx4 v254, s[12:15], s30 offen offset:3072 nt lds
    v_exp_f32 v190, v190
    v_mfma_f32_16x16x32_bf16 a[124:127], v[232:235], v[172:175], a[124:127]
    v_fma_f32 v191, v191, s26, v243
    v_fma_f32 v196, v196, s26, v244
    v_mfma_f32_16x16x32_bf16 a[60:63], v[232:235], v[160:163], a[60:63]
    ds_read_b128 v[220:223], v253 offset:4096
    v_add_f32 v248, v190, v248
    v_mfma_f32_16x16x32_bf16 v[60:63], v[232:235], v[148:151], v[60:63]
    s_waitcnt lgkmcnt(2)
    ds_read_b128 v[224:227], v253 offset:4352
    v_fma_f32 v197, v197, s26, v244
.p2align 6
L_loop:
    v_mfma_f32_16x16x32_bf16 v[152:155], v[212:215], v[64:67], 0
    s_waitcnt lgkmcnt(2)
    ds_read_b128 v[228:231], v250 offset:16640
    v_fma_f32 v198, v198, s26, v244
    v_mfma_f32_16x16x32_bf16 v[152:155], v[216:219], v[68:71], v[152:155]
    ds_read_b128 v[232:235], v250 offset:16384
    v_mfma_f32_16x16x32_bf16 v[164:167], v[216:219], v[100:103], 0
    s_mov_b32 m0, s22
    v_exp_f32 v191, v191
    v_mfma_f32_16x16x32_bf16 v[164:167], v[212:215], v[96:99], v[164:167]
    s_waitcnt lgkmcnt(3)
    buffer_load_dwordx4 v254, s[8:11], s20 offen offset:0 nt lds
    v_mfma_f32_16x16x32_bf16 v[192:195], v[212:215], v[220:223], 0
    s_waitcnt lgkmcnt(2)
    v_exp_f32 v196, v196
    v_mfma_f32_16x16x32_bf16 v[192:195], v[216:219], v[224:227], v[192:195]
    s_waitcnt lgkmcnt(1)
    v_exp_f32 v197, v197
    v_mfma_f32_16x16x32_bf16 v[184:187], v[228:231], v[224:227], 0
    s_waitcnt lgkmcnt(0)
    ds_read_b128 v[148:151], v253 offset:12288
    v_cvt_pk_bf16_f32 v183, v190, v191
    v_mfma_f32_16x16x32_bf16 v[184:187], v[232:235], v[220:223], v[184:187]
    ds_read_b128 v[160:163], v253 offset:12544
    v_add_f32 v248, v191, v248
    v_mfma_f32_16x16x32_bf16 v[172:175], v[232:235], v[128:131], 0
    v_exp_f32 v198, v198
    v_mfma_f32_16x16x32_bf16 v[172:175], v[228:231], v[132:135], v[172:175]
    buffer_load_dwordx4 v254, s[8:11], s20 offen offset:1024 nt lds
    v_mfma_f32_16x16x32_bf16 v[176:179], v[216:219], v[132:135], 0
    v_add_f32 v249, v196, v249
    v_cvt_pk_bf16_f32 v196, v196, v197
    v_mfma_f32_16x16x32_bf16 v[176:179], v[212:215], v[128:131], v[176:179]
    s_waitcnt lgkmcnt(1)
    v_add_f32 v249, v197, v249
    v_add_f32 v249, v198, v249
    v_mfma_f32_16x16x32_bf16 v[208:211], v[212:215], v[148:151], 0
    s_waitcnt lgkmcnt(0)
    v_fma_f32 v199, v199, s26, v244
    v_fma_f32 v204, v204, s26, v244
    v_mfma_f32_16x16x32_bf16 v[208:211], v[216:219], v[160:163], v[208:211]
    buffer_load_dwordx4 v254, s[8:11], s20 offen offset:2048 nt lds
    v_mfma_f32_16x16x32_bf16 v[200:203], v[228:231], v[160:163], 0
    ds_read_b128 v[188:191], v250 offset:16896
    v_fma_f32 v205, v205, s26, v244
    v_mfma_f32_16x16x32_bf16 v[200:203], v[232:235], v[148:151], v[200:203]
    ds_read_b128 v[224:227], v250 offset:17152
    v_fma_f32 v206, v206, s26, v244
    v_mfma_f32_16x16x32_bf16 v[160:163], v[232:235], v[96:99], 0
    v_exp_f32 v199, v199
    v_mfma_f32_16x16x32_bf16 v[160:163], v[228:231], v[100:103], v[160:163]
    ds_read_b128 v[220:223], v253 offset:4864
    v_fma_f32 v207, v207, s26, v244
    v_mfma_f32_16x16x32_bf16 v[148:151], v[228:231], v[68:71], 0
    ds_read_b128 v[212:215], v253 offset:4608
    v_cvt_pk_bf16_f32 v197, v198, v199
    v_mfma_f32_16x16x32_bf16 v[148:151], v[232:235], v[64:67], v[148:151]
    s_waitcnt lgkmcnt(3)
    buffer_load_dwordx4 v254, s[8:11], s20 offen offset:3072 nt lds
    v_mfma_f32_16x16x32_bf16 v[148:151], v[188:191], v[72:75], v[148:151]
    s_waitcnt lgkmcnt(2)
    ds_read_b128 v[216:219], v250 offset:19200
    v_add_f32 v249, v199, v249
    v_mfma_f32_16x16x32_bf16 v[148:151], v[224:227], v[76:79], v[148:151]
    s_add_u32 s20, s20, 16384
    ds_read_b128 v[228:231], v250 offset:18944
    v_mfma_f32_16x16x32_bf16 v[160:163], v[224:227], v[108:111], v[160:163]
    v_exp_f32 v204, v204
    v_mfma_f32_16x16x32_bf16 v[160:163], v[188:191], v[104:107], v[160:163]
    s_waitcnt lgkmcnt(2)
    v_exp_f32 v205, v205
    v_mfma_f32_16x16x32_bf16 v[184:187], v[188:191], v[212:215], v[184:187]
    s_waitcnt lgkmcnt(3)
    v_exp_f32 v206, v206
    v_mfma_f32_16x16x32_bf16 v[184:187], v[224:227], v[220:223], v[184:187]
    s_waitcnt lgkmcnt(1)
    v_exp_f32 v207, v207
    v_mfma_f32_16x16x32_bf16 v[192:195], v[216:219], v[220:223], v[192:195]
    s_waitcnt lgkmcnt(0)
    ds_read_b128 v[232:235], v253 offset:12800
    v_cvt_pk_bf16_f32 v198, v204, v205
    v_mfma_f32_16x16x32_bf16 v[192:195], v[228:231], v[212:215], v[192:195]
    s_mov_b32 m0, s25
    ds_read_b128 v[220:223], v253 offset:13056
    v_cvt_pk_bf16_f32 v199, v206, v207
    v_mfma_f32_16x16x32_bf16 v[176:179], v[228:231], v[136:139], v[176:179]
    buffer_load_dwordx4 v254, s[12:15], s21 offen offset:0 nt lds
    v_mfma_f32_16x16x32_bf16 v[176:179], v[216:219], v[140:143], v[176:179]
    v_add_f32 v249, v204, v249
    v_add_f32 v249, v205, v249
    v_mfma_f32_16x16x32_bf16 v[172:175], v[224:227], v[140:143], v[172:175]
    v_add_f32 v249, v206, v249
    v_add_f32 v249, v207, v249
    v_mfma_f32_16x16x32_bf16 v[172:175], v[188:191], v[136:139], v[172:175]
    s_waitcnt lgkmcnt(1)
    v_mfma_f32_16x16x32_bf16 v[200:203], v[188:191], v[232:235], v[200:203]
    s_waitcnt lgkmcnt(0)
    v_mfma_f32_16x16x32_bf16 v[200:203], v[224:227], v[220:223], v[200:203]
    buffer_load_dwordx4 v254, s[12:15], s21 offen offset:1024 nt lds
    v_mfma_f32_16x16x32_bf16 v[208:211], v[216:219], v[220:223], v[208:211]
    ds_read_b128 v[204:207], v250 offset:26624
    v_mfma_f32_16x16x32_bf16 v[208:211], v[228:231], v[232:235], v[208:211]
    ds_read_b128 v[188:191], v250 offset:26880
    v_mfma_f32_16x16x32_bf16 v[164:167], v[228:231], v[104:107], v[164:167]
    v_mfma_f32_16x16x32_bf16 v[164:167], v[216:219], v[108:111], v[164:167]
    ds_read_b128 v[212:215], v253 offset:256
    v_mfma_f32_16x16x32_bf16 v[152:155], v[216:219], v[76:79], v[152:155]
    ds_read_b128 v[224:227], v253 offset:0
    v_mfma_f32_16x16x32_bf16 v[152:155], v[228:231], v[72:75], v[152:155]
    s_waitcnt lgkmcnt(3)
    buffer_load_dwordx4 v254, s[12:15], s21 offen offset:2048 nt lds
    v_mfma_f32_16x16x32_bf16 v[152:155], v[204:207], v[80:83], v[152:155]
    s_waitcnt lgkmcnt(2)
    ds_read_b128 v[220:223], v250 offset:24832
    v_mfma_f32_16x16x32_bf16 v[152:155], v[188:191], v[84:87], v[152:155]
    ds_read_b128 v[232:235], v250 offset:24576
    v_mfma_f32_16x16x32_bf16 v[164:167], v[188:191], v[116:119], v[164:167]
    ds_read_b128 v[216:219], v253 offset:8192
    v_mfma_f32_16x16x32_bf16 v[164:167], v[204:207], v[112:115], v[164:167]
    s_waitcnt lgkmcnt(3)
    ds_read_b128 v[228:231], v253 offset:8448
    v_mfma_f32_16x16x32_bf16 v[176:179], v[204:207], v[224:227], v[176:179]
    s_waitcnt lgkmcnt(5)
    v_mfma_f32_16x16x32_bf16 v[176:179], v[188:191], v[212:215], v[176:179]
    s_waitcnt lgkmcnt(3)
    v_mfma_f32_16x16x32_bf16 v[172:175], v[220:223], v[212:215], v[172:175]
    s_waitcnt lgkmcnt(2)
    ds_read_b128 v[212:215], v253 offset:16384
    v_mfma_f32_16x16x32_bf16 v[172:175], v[232:235], v[224:227], v[172:175]
    s_waitcnt lgkmcnt(2)
    ds_read_b128 v[224:227], v253 offset:16640
    v_mfma_f32_16x16x32_bf16 v[184:187], v[232:235], v[216:219], v[184:187]
    s_waitcnt lgkmcnt(2)
    v_mfma_f32_16x16x32_bf16 v[184:187], v[220:223], v[228:231], v[184:187]
    v_mfma_f32_16x16x32_bf16 v[192:195], v[188:191], v[228:231], v[192:195]
    v_mfma_f32_16x16x32_bf16 v[192:195], v[204:207], v[216:219], v[192:195]
    s_waitcnt lgkmcnt(1)
    buffer_load_dwordx4 v254, s[12:15], s21 offen offset:3072 nt lds
    v_mfma_f32_16x16x32_bf16 v[208:211], v[204:207], v[212:215], v[208:211]
    s_waitcnt lgkmcnt(0)
    v_mfma_f32_16x16x32_bf16 v[208:211], v[188:191], v[224:227], v[208:211]
    s_add_u32 s21, s21, 16384
    v_mfma_f32_16x16x32_bf16 v[200:203], v[220:223], v[224:227], v[200:203]
    s_cmp_le_u32 s27, 3
    ds_read_b128 v[204:207], v250 offset:25088
    v_mfma_f32_16x16x32_bf16 v[200:203], v[232:235], v[212:215], v[200:203]
    s_cselect_b32 s94, 0x80000, 0
    ds_read_b128 v[188:191], v250 offset:25344
    v_mfma_f32_16x16x32_bf16 v[160:163], v[232:235], v[112:115], v[160:163]
    v_mfma_f32_16x16x32_bf16 v[160:163], v[220:223], v[116:119], v[160:163]
    v_mfma_f32_16x16x32_bf16 v[148:151], v[220:223], v[84:87], v[148:151]
    ds_read_b128 v[228:231], v253 offset:512
    v_mfma_f32_16x16x32_bf16 v[148:151], v[232:235], v[80:83], v[148:151]
    s_waitcnt lgkmcnt(2)
    ds_read_b128 v[216:219], v253 offset:768
    v_mfma_f32_16x16x32_bf16 v[148:151], v[204:207], v[88:91], v[148:151]
    s_waitcnt lgkmcnt(2)
    ds_read_b128 v[224:227], v250 offset:27392
    v_mfma_f32_16x16x32_bf16 v[148:151], v[188:191], v[92:95], v[148:151]
    ds_read_b128 v[212:215], v250 offset:27136
    v_mfma_f32_16x16x32_bf16 v[160:163], v[188:191], v[124:127], v[160:163]
    ds_read_b128 v[220:223], v253 offset:8704
    v_mfma_f32_16x16x32_bf16 v[160:163], v[204:207], v[120:123], v[160:163]
    s_waitcnt lgkmcnt(4)
    ds_read_b128 v[232:235], v253 offset:8960
    v_mfma_f32_16x16x32_bf16 v[172:175], v[204:207], v[228:231], v[172:175]
    s_waitcnt lgkmcnt(4)
    buffer_load_dword v237, v236, s[92:95], s20 offen offset:0
    v_mfma_f32_16x16x32_bf16 v[172:175], v[188:191], v[216:219], v[172:175]
    s_waitcnt lgkmcnt(3)
    v_mfma_f32_16x16x32_bf16 v[176:179], v[224:227], v[216:219], v[176:179]
    s_waitcnt lgkmcnt(2)
    ds_read_b128 v[216:219], v253 offset:16896
    v_mfma_f32_16x16x32_bf16 v[176:179], v[212:215], v[228:231], v[176:179]
    s_waitcnt lgkmcnt(2)
    ds_read_b128 v[228:231], v253 offset:17152
    v_mfma_f32_16x16x32_bf16 v[192:195], v[212:215], v[220:223], v[192:195]
    s_waitcnt lgkmcnt(2)
    v_mfma_f32_16x16x32_bf16 v[192:195], v[224:227], v[232:235], v[192:195]
    v_mfma_f32_16x16x32_bf16 v[184:187], v[188:191], v[232:235], v[184:187]
    v_fma_f32 v148, v148, s26, v240
    v_fma_f32 v149, v149, s26, v240
    v_mfma_f32_16x16x32_bf16 v[184:187], v[204:207], v[220:223], v[184:187]
    s_waitcnt lgkmcnt(1)
    v_exp_f32 v148, v148
    v_mfma_f32_16x16x32_bf16 v[200:203], v[204:207], v[216:219], v[200:203]
    s_waitcnt lgkmcnt(0)
    v_exp_f32 v149, v149
    v_mfma_f32_16x16x32_bf16 v[200:203], v[188:191], v[228:231], v[200:203]
    ds_read_b64_tr_b16 v[204:205], v251 offset:32768
    v_add_f32 v245, v148, v245
    v_mfma_f32_16x16x32_bf16 v[208:211], v[224:227], v[228:231], v[208:211]
    ds_read_b64_tr_b16 v[206:207], v251 offset:34816
    v_cvt_pk_bf16_f32 v148, v148, v149
    v_mfma_f32_16x16x32_bf16 v[208:211], v[212:215], v[216:219], v[208:211]
    v_add_f32 v245, v149, v245
    v_fma_f32 v150, v150, s26, v240
    v_mfma_f32_16x16x32_bf16 v[164:167], v[212:215], v[120:123], v[164:167]
    v_exp_f32 v150, v150
    v_mfma_f32_16x16x32_bf16 v[164:167], v[224:227], v[124:127], v[164:167]
    v_fma_f32 v151, v151, s26, v240
    v_fma_f32 v160, v160, s26, v241
    v_mfma_f32_16x16x32_bf16 v[152:155], v[224:227], v[92:95], v[152:155]
    ds_read_b64_tr_b16 v[188:189], v252 offset:32768
    v_add_f32 v245, v150, v245
    v_mfma_f32_16x16x32_bf16 v[152:155], v[212:215], v[88:91], v[152:155]
    s_waitcnt lgkmcnt(1)
    ds_read_b64_tr_b16 v[190:191], v252 offset:34816
    v_fma_f32 v161, v161, s26, v241
    v_mfma_f32_16x16x32_bf16 v[0:3], v[204:207], v[144:147], v[0:3]
    v_exp_f32 v151, v151
    v_mfma_f32_16x16x32_bf16 a[0:3], v[204:207], v[156:159], a[0:3]
    v_exp_f32 v160, v160
    v_mfma_f32_16x16x32_bf16 a[64:67], v[204:207], v[168:171], a[64:67]
    v_exp_f32 v161, v161
    v_mfma_f32_16x16x32_bf16 a[128:131], v[204:207], v[180:183], a[128:131]
    ds_read_b64_tr_b16 v[232:233], v251 offset:33024
    v_cvt_pk_bf16_f32 v149, v150, v151
    v_mfma_f32_16x16x32_bf16 a[192:195], v[204:207], v[196:199], a[192:195]
    s_waitcnt lgkmcnt(1)
    ds_read_b64_tr_b16 v[234:235], v251 offset:35072
    v_add_f32 v245, v151, v245
    v_mfma_f32_16x16x32_bf16 a[196:199], v[188:191], v[196:199], a[196:199]
    v_fma_f32 v152, v152, s26, v240
    v_fma_f32 v153, v153, s26, v240
    v_mfma_f32_16x16x32_bf16 a[132:135], v[188:191], v[180:183], a[132:135]
    v_exp_f32 v152, v152
    v_mfma_f32_16x16x32_bf16 a[68:71], v[188:191], v[168:171], a[68:71]
    v_exp_f32 v153, v153
    v_mfma_f32_16x16x32_bf16 a[4:7], v[188:191], v[156:159], a[4:7]
    ds_read_b64_tr_b16 v[204:205], v252 offset:33024
    v_add_f32 v245, v152, v245
    v_mfma_f32_16x16x32_bf16 v[4:7], v[188:191], v[144:147], v[4:7]
    s_waitcnt lgkmcnt(1)
    ds_read_b64_tr_b16 v[206:207], v252 offset:35072
    v_cvt_pk_bf16_f32 v150, v152, v153
    v_mfma_f32_16x16x32_bf16 v[8:11], v[232:235], v[144:147], v[8:11]
    v_add_f32 v245, v153, v245
    v_fma_f32 v154, v154, s26, v240
    v_mfma_f32_16x16x32_bf16 a[8:11], v[232:235], v[156:159], a[8:11]
    v_exp_f32 v154, v154
    v_mfma_f32_16x16x32_bf16 a[72:75], v[232:235], v[168:171], a[72:75]
    v_fma_f32 v155, v155, s26, v240
    v_add_f32 v246, v160, v246
    v_mfma_f32_16x16x32_bf16 a[136:139], v[232:235], v[180:183], a[136:139]
    ds_read_b64_tr_b16 v[188:189], v251 offset:33280
    v_add_f32 v245, v154, v245
    v_mfma_f32_16x16x32_bf16 a[200:203], v[232:235], v[196:199], a[200:203]
    s_waitcnt lgkmcnt(1)
    ds_read_b64_tr_b16 v[190:191], v251 offset:35328
    v_cvt_pk_bf16_f32 v160, v160, v161
    v_mfma_f32_16x16x32_bf16 a[204:207], v[204:207], v[196:199], a[204:207]
    v_exp_f32 v155, v155
    v_mfma_f32_16x16x32_bf16 a[140:143], v[204:207], v[180:183], a[140:143]
    v_add_f32 v246, v161, v246
    v_fma_f32 v162, v162, s26, v241
    v_mfma_f32_16x16x32_bf16 a[76:79], v[204:207], v[168:171], a[76:79]
    v_exp_f32 v162, v162
    v_mfma_f32_16x16x32_bf16 a[12:15], v[204:207], v[156:159], a[12:15]
    ds_read_b64_tr_b16 v[220:221], v252 offset:33280
    v_cvt_pk_bf16_f32 v151, v154, v155
    v_mfma_f32_16x16x32_bf16 v[12:15], v[204:207], v[144:147], v[12:15]
    s_waitcnt lgkmcnt(1)
    ds_read_b64_tr_b16 v[222:223], v252 offset:35328
    v_add_f32 v245, v155, v245
    v_mfma_f32_16x16x32_bf16 v[16:19], v[188:191], v[144:147], v[16:19]
    v_add_f32 v246, v162, v246
    v_fma_f32 v163, v163, s26, v241
    v_mfma_f32_16x16x32_bf16 a[16:19], v[188:191], v[156:159], a[16:19]
    v_exp_f32 v163, v163
    v_mfma_f32_16x16x32_bf16 a[80:83], v[188:191], v[168:171], a[80:83]
    v_fma_f32 v164, v164, s26, v241
    v_fma_f32 v165, v165, s26, v241
    v_mfma_f32_16x16x32_bf16 a[144:147], v[188:191], v[180:183], a[144:147]
    ds_read_b64_tr_b16 v[204:205], v251 offset:33536
    v_cvt_pk_bf16_f32 v161, v162, v163
    v_mfma_f32_16x16x32_bf16 a[208:211], v[188:191], v[196:199], a[208:211]
    s_waitcnt lgkmcnt(1)
    ds_read_b64_tr_b16 v[206:207], v251 offset:35584
    v_add_f32 v246, v163, v246
    v_mfma_f32_16x16x32_bf16 a[212:215], v[220:223], v[196:199], a[212:215]
    v_exp_f32 v164, v164
    v_mfma_f32_16x16x32_bf16 a[148:151], v[220:223], v[180:183], a[148:151]
    v_exp_f32 v165, v165
    v_mfma_f32_16x16x32_bf16 a[84:87], v[220:223], v[168:171], a[84:87]
    v_add_f32 v246, v164, v246
    v_fma_f32 v166, v166, s26, v241
    v_mfma_f32_16x16x32_bf16 a[20:23], v[220:223], v[156:159], a[20:23]
    ds_read_b64_tr_b16 v[188:189], v252 offset:33536
    v_cvt_pk_bf16_f32 v162, v164, v165
    v_mfma_f32_16x16x32_bf16 v[20:23], v[220:223], v[144:147], v[20:23]
    s_waitcnt lgkmcnt(1)
    ds_read_b64_tr_b16 v[190:191], v252 offset:35584
    v_add_f32 v246, v165, v246
    v_mfma_f32_16x16x32_bf16 v[24:27], v[204:207], v[144:147], v[24:27]
    v_exp_f32 v166, v166
    v_mfma_f32_16x16x32_bf16 a[24:27], v[204:207], v[156:159], a[24:27]
    v_fma_f32 v167, v167, s26, v241
    v_fma_f32 v172, v172, s26, v242
    v_mfma_f32_16x16x32_bf16 a[88:91], v[204:207], v[168:171], a[88:91]
    v_exp_f32 v167, v167
    v_mfma_f32_16x16x32_bf16 a[152:155], v[204:207], v[180:183], a[152:155]
    ds_read_b64_tr_b16 v[228:229], v251 offset:40960
    v_add_f32 v246, v166, v246
    v_mfma_f32_16x16x32_bf16 a[216:219], v[204:207], v[196:199], a[216:219]
    s_waitcnt lgkmcnt(1)
    ds_read_b64_tr_b16 v[230:231], v251 offset:43008
    v_cvt_pk_bf16_f32 v163, v166, v167
    v_mfma_f32_16x16x32_bf16 a[220:223], v[188:191], v[196:199], a[220:223]
    v_exp_f32 v172, v172
    v_mfma_f32_16x16x32_bf16 a[156:159], v[188:191], v[180:183], a[156:159]
    v_add_f32 v246, v167, v246
    v_fma_f32 v173, v173, s26, v242
    v_mfma_f32_16x16x32_bf16 a[92:95], v[188:191], v[168:171], a[92:95]
    v_exp_f32 v173, v173
    v_mfma_f32_16x16x32_bf16 a[28:31], v[188:191], v[156:159], a[28:31]
    ds_read_b64_tr_b16 v[204:205], v252 offset:40960
    v_add_f32 v247, v172, v247
    v_mfma_f32_16x16x32_bf16 v[28:31], v[188:191], v[144:147], v[28:31]
    s_waitcnt lgkmcnt(1)
    ds_read_b64_tr_b16 v[206:207], v252 offset:43008
    v_cvt_pk_bf16_f32 v172, v172, v173
    v_mfma_f32_16x16x32_bf16 v[32:35], v[228:231], v[144:147], v[32:35]
    v_add_f32 v247, v173, v247
    v_fma_f32 v174, v174, s26, v242
    v_mfma_f32_16x16x32_bf16 a[32:35], v[228:231], v[156:159], a[32:35]
    v_exp_f32 v174, v174
    v_mfma_f32_16x16x32_bf16 a[96:99], v[228:231], v[168:171], a[96:99]
    v_fma_f32 v175, v175, s26, v242
    v_fma_f32 v176, v176, s26, v242
    v_mfma_f32_16x16x32_bf16 a[160:163], v[228:231], v[180:183], a[160:163]
    ds_read_b64_tr_b16 v[188:189], v251 offset:41216
    v_add_f32 v247, v174, v247
    v_mfma_f32_16x16x32_bf16 a[224:227], v[228:231], v[196:199], a[224:227]
    s_waitcnt lgkmcnt(1)
    ds_read_b64_tr_b16 v[190:191], v251 offset:43264
    v_fma_f32 v177, v177, s26, v242
    v_mfma_f32_16x16x32_bf16 a[228:231], v[204:207], v[196:199], a[228:231]
    v_exp_f32 v175, v175
    v_mfma_f32_16x16x32_bf16 a[164:167], v[204:207], v[180:183], a[164:167]
    v_exp_f32 v176, v176
    v_mfma_f32_16x16x32_bf16 a[100:103], v[204:207], v[168:171], a[100:103]
    v_exp_f32 v177, v177
    v_mfma_f32_16x16x32_bf16 a[36:39], v[204:207], v[156:159], a[36:39]
    ds_read_b64_tr_b16 v[216:217], v252 offset:41216
    v_cvt_pk_bf16_f32 v173, v174, v175
    v_mfma_f32_16x16x32_bf16 v[36:39], v[204:207], v[144:147], v[36:39]
    s_waitcnt lgkmcnt(1)
    ds_read_b64_tr_b16 v[218:219], v252 offset:43264
    v_cvt_pk_bf16_f32 v174, v176, v177
    v_mfma_f32_16x16x32_bf16 v[40:43], v[188:191], v[144:147], v[40:43]
    v_add_f32 v247, v175, v247
    v_add_f32 v247, v176, v247
    v_mfma_f32_16x16x32_bf16 a[40:43], v[188:191], v[156:159], a[40:43]
    v_add_f32 v247, v177, v247
    v_fma_f32 v178, v178, s26, v242
    v_mfma_f32_16x16x32_bf16 a[104:107], v[188:191], v[168:171], a[104:107]
    v_exp_f32 v178, v178
    v_mfma_f32_16x16x32_bf16 a[168:171], v[188:191], v[180:183], a[168:171]
    ds_read_b64_tr_b16 v[204:205], v251 offset:41472
    v_fma_f32 v179, v179, s26, v242
    v_mfma_f32_16x16x32_bf16 a[232:235], v[188:191], v[196:199], a[232:235]
    s_waitcnt lgkmcnt(1)
    ds_read_b64_tr_b16 v[206:207], v251 offset:43520
    v_add_f32 v247, v178, v247
    v_mfma_f32_16x16x32_bf16 a[236:239], v[216:219], v[196:199], a[236:239]
    v_exp_f32 v179, v179
    v_mfma_f32_16x16x32_bf16 a[172:175], v[216:219], v[180:183], a[172:175]
    ds_read_b64_tr_b16 v[188:189], v252 offset:41472
    v_fma_f32 v184, v184, s26, v243
    v_mfma_f32_16x16x32_bf16 a[108:111], v[216:219], v[168:171], a[108:111]
    ds_read_b64_tr_b16 v[190:191], v252 offset:43520
    v_cvt_pk_bf16_f32 v175, v178, v179
    v_mfma_f32_16x16x32_bf16 a[44:47], v[216:219], v[156:159], a[44:47]
    ds_read_b64_tr_b16 v[224:225], v251 offset:41728
    v_add_f32 v247, v179, v247
    v_mfma_f32_16x16x32_bf16 v[44:47], v[216:219], v[144:147], v[44:47]
    s_waitcnt lgkmcnt(3)
    ds_read_b64_tr_b16 v[226:227], v251 offset:43776
    v_fma_f32 v185, v185, s26, v243
    v_mfma_f32_16x16x32_bf16 v[48:51], v[204:207], v[144:147], v[48:51]
    ds_read_b64_tr_b16 v[232:233], v252 offset:41728
    v_fma_f32 v186, v186, s26, v243
    v_mfma_f32_16x16x32_bf16 a[48:51], v[204:207], v[156:159], a[48:51]
    ds_read_b64_tr_b16 v[234:235], v252 offset:43776
    v_fma_f32 v187, v187, s26, v243
    v_mfma_f32_16x16x32_bf16 a[112:115], v[204:207], v[168:171], a[112:115]
    v_exp_f32 v184, v184
    v_mfma_f32_16x16x32_bf16 a[176:179], v[204:207], v[180:183], a[176:179]
    v_exp_f32 v185, v185
    v_mfma_f32_16x16x32_bf16 a[240:243], v[204:207], v[196:199], a[240:243]
    s_waitcnt lgkmcnt(4)
    v_exp_f32 v186, v186
    v_mfma_f32_16x16x32_bf16 a[244:247], v[188:191], v[196:199], a[244:247]
    v_exp_f32 v187, v187
    v_mfma_f32_16x16x32_bf16 a[180:183], v[188:191], v[180:183], a[180:183]
    s_waitcnt vmcnt(1) lgkmcnt(0)
    s_barrier
    v_mfma_f32_16x16x32_bf16 a[116:119], v[188:191], v[168:171], a[116:119]
    v_add_f32 v248, v184, v248
    v_cvt_pk_bf16_f32 v184, v184, v185
    v_mfma_f32_16x16x32_bf16 a[52:55], v[188:191], v[156:159], a[52:55]
    v_add_f32 v248, v185, v248
    v_cvt_pk_bf16_f32 v185, v186, v187
    v_mfma_f32_16x16x32_bf16 v[52:55], v[188:191], v[144:147], v[52:55]
    v_add_f32 v248, v186, v248
    v_add_f32 v248, v187, v248
    v_mfma_f32_16x16x32_bf16 v[56:59], v[224:227], v[144:147], v[56:59]
    v_fma_f32 v192, v192, s26, v243
    v_fma_f32 v193, v193, s26, v243
    v_mfma_f32_16x16x32_bf16 a[56:59], v[224:227], v[156:159], a[56:59]
    v_exp_f32 v192, v192
    v_mfma_f32_16x16x32_bf16 a[120:123], v[224:227], v[168:171], a[120:123]
    v_exp_f32 v193, v193
    v_mfma_f32_16x16x32_bf16 a[184:187], v[224:227], v[180:183], a[184:187]
    v_add_f32 v248, v192, v248
    v_fma_f32 v194, v194, s26, v243
    v_mfma_f32_16x16x32_bf16 a[248:251], v[224:227], v[196:199], a[248:251]
    ds_read_b128 v[212:215], v250 offset:2048
    v_cvt_pk_bf16_f32 v186, v192, v193
    v_mfma_f32_16x16x32_bf16 a[252:255], v[232:235], v[196:199], a[252:255]
    ds_read_b128 v[216:219], v250 offset:2304
    v_add_f32 v248, v193, v248
    v_mfma_f32_16x16x32_bf16 a[188:191], v[232:235], v[180:183], a[188:191]
    v_exp_f32 v194, v194
    v_mfma_f32_16x16x32_bf16 a[124:127], v[232:235], v[168:171], a[124:127]
    v_fma_f32 v195, v195, s26, v243
    v_fma_f32 v200, v200, s26, v244
    v_mfma_f32_16x16x32_bf16 a[60:63], v[232:235], v[156:159], a[60:63]
    ds_read_b128 v[220:223], v253 offset:4096
    v_add_f32 v248, v194, v248
    v_mfma_f32_16x16x32_bf16 v[60:63], v[232:235], v[144:147], v[60:63]
    s_waitcnt lgkmcnt(2)
    ds_read_b128 v[224:227], v253 offset:4352
    v_fma_f32 v201, v201, s26, v244
    v_mfma_f32_16x16x32_bf16 v[152:155], v[212:215], v[64:67], 0
    s_waitcnt lgkmcnt(2)
    ds_read_b128 v[228:231], v250 offset:256
    v_fma_f32 v202, v202, s26, v244
    v_mfma_f32_16x16x32_bf16 v[152:155], v[216:219], v[68:71], v[152:155]
    ds_read_b128 v[232:235], v250 offset:0
    v_mfma_f32_16x16x32_bf16 v[164:167], v[216:219], v[100:103], 0
    s_mov_b32 m0, s23
    v_exp_f32 v195, v195
    v_mfma_f32_16x16x32_bf16 v[164:167], v[212:215], v[96:99], v[164:167]
    s_waitcnt lgkmcnt(3)
    buffer_load_dwordx4 v254, s[8:11], s20 offen offset:0 nt lds
    v_mfma_f32_16x16x32_bf16 v[188:191], v[212:215], v[220:223], 0
    s_waitcnt lgkmcnt(2)
    v_exp_f32 v200, v200
    v_mfma_f32_16x16x32_bf16 v[188:191], v[216:219], v[224:227], v[188:191]
    s_waitcnt lgkmcnt(1)
    v_exp_f32 v201, v201
    v_mfma_f32_16x16x32_bf16 v[180:183], v[228:231], v[224:227], 0
    s_waitcnt lgkmcnt(0)
    ds_read_b128 v[144:147], v253 offset:12288
    v_cvt_pk_bf16_f32 v187, v194, v195
    v_mfma_f32_16x16x32_bf16 v[180:183], v[232:235], v[220:223], v[180:183]
    ds_read_b128 v[156:159], v253 offset:12544
    v_add_f32 v248, v195, v248
    v_mfma_f32_16x16x32_bf16 v[168:171], v[232:235], v[128:131], 0
    v_exp_f32 v202, v202
    v_mfma_f32_16x16x32_bf16 v[168:171], v[228:231], v[132:135], v[168:171]
    buffer_load_dwordx4 v254, s[8:11], s20 offen offset:1024 nt lds
    v_mfma_f32_16x16x32_bf16 v[176:179], v[216:219], v[132:135], 0
    v_add_f32 v249, v200, v249
    v_cvt_pk_bf16_f32 v200, v200, v201
    v_mfma_f32_16x16x32_bf16 v[176:179], v[212:215], v[128:131], v[176:179]
    s_waitcnt lgkmcnt(1)
    v_add_f32 v249, v201, v249
    v_add_f32 v249, v202, v249
    v_mfma_f32_16x16x32_bf16 v[204:207], v[212:215], v[144:147], 0
    s_waitcnt lgkmcnt(0)
    v_fma_f32 v203, v203, s26, v244
    v_fma_f32 v208, v208, s26, v244
    v_mfma_f32_16x16x32_bf16 v[204:207], v[216:219], v[156:159], v[204:207]
    buffer_load_dwordx4 v254, s[8:11], s20 offen offset:2048 nt lds
    v_mfma_f32_16x16x32_bf16 v[196:199], v[228:231], v[156:159], 0
    ds_read_b128 v[192:195], v250 offset:512
    v_fma_f32 v209, v209, s26, v244
    v_mfma_f32_16x16x32_bf16 v[196:199], v[232:235], v[144:147], v[196:199]
    ds_read_b128 v[224:227], v250 offset:768
    v_fma_f32 v210, v210, s26, v244
    v_mfma_f32_16x16x32_bf16 v[156:159], v[232:235], v[96:99], 0
    v_exp_f32 v203, v203
    v_mfma_f32_16x16x32_bf16 v[156:159], v[228:231], v[100:103], v[156:159]
    ds_read_b128 v[220:223], v253 offset:4864
    v_fma_f32 v211, v211, s26, v244
    v_mfma_f32_16x16x32_bf16 v[144:147], v[228:231], v[68:71], 0
    ds_read_b128 v[212:215], v253 offset:4608
    v_cvt_pk_bf16_f32 v201, v202, v203
    v_mfma_f32_16x16x32_bf16 v[144:147], v[232:235], v[64:67], v[144:147]
    s_waitcnt lgkmcnt(3)
    buffer_load_dwordx4 v254, s[8:11], s20 offen offset:3072 nt lds
    v_mfma_f32_16x16x32_bf16 v[144:147], v[192:195], v[72:75], v[144:147]
    s_waitcnt lgkmcnt(2)
    ds_read_b128 v[216:219], v250 offset:2816
    v_add_f32 v249, v203, v249
    v_mfma_f32_16x16x32_bf16 v[144:147], v[224:227], v[76:79], v[144:147]
    s_add_u32 s20, s20, 16384
    ds_read_b128 v[228:231], v250 offset:2560
    v_mfma_f32_16x16x32_bf16 v[156:159], v[224:227], v[108:111], v[156:159]
    v_exp_f32 v208, v208
    v_mfma_f32_16x16x32_bf16 v[156:159], v[192:195], v[104:107], v[156:159]
    s_waitcnt lgkmcnt(2)
    v_exp_f32 v209, v209
    v_mfma_f32_16x16x32_bf16 v[180:183], v[192:195], v[212:215], v[180:183]
    s_waitcnt lgkmcnt(3)
    v_exp_f32 v210, v210
    v_mfma_f32_16x16x32_bf16 v[180:183], v[224:227], v[220:223], v[180:183]
    s_waitcnt lgkmcnt(1)
    v_exp_f32 v211, v211
    v_mfma_f32_16x16x32_bf16 v[188:191], v[216:219], v[220:223], v[188:191]
    s_waitcnt lgkmcnt(0)
    ds_read_b128 v[232:235], v253 offset:12800
    v_cvt_pk_bf16_f32 v202, v208, v209
    v_mfma_f32_16x16x32_bf16 v[188:191], v[228:231], v[212:215], v[188:191]
    s_mov_b32 m0, s24
    ds_read_b128 v[220:223], v253 offset:13056
    v_cvt_pk_bf16_f32 v203, v210, v211
    v_mfma_f32_16x16x32_bf16 v[176:179], v[228:231], v[136:139], v[176:179]
    buffer_load_dwordx4 v254, s[12:15], s21 offen offset:0 nt lds
    v_mfma_f32_16x16x32_bf16 v[176:179], v[216:219], v[140:143], v[176:179]
    v_add_f32 v249, v208, v249
    v_add_f32 v249, v209, v249
    v_mfma_f32_16x16x32_bf16 v[168:171], v[224:227], v[140:143], v[168:171]
    v_add_f32 v249, v210, v249
    v_add_f32 v249, v211, v249
    v_mfma_f32_16x16x32_bf16 v[168:171], v[192:195], v[136:139], v[168:171]
    s_waitcnt lgkmcnt(1)
    v_mfma_f32_16x16x32_bf16 v[196:199], v[192:195], v[232:235], v[196:199]
    s_waitcnt lgkmcnt(0)
    v_mfma_f32_16x16x32_bf16 v[196:199], v[224:227], v[220:223], v[196:199]
    buffer_load_dwordx4 v254, s[12:15], s21 offen offset:1024 nt lds
    v_mfma_f32_16x16x32_bf16 v[204:207], v[216:219], v[220:223], v[204:207]
    ds_read_b128 v[208:211], v250 offset:10240
    v_mfma_f32_16x16x32_bf16 v[204:207], v[228:231], v[232:235], v[204:207]
    ds_read_b128 v[192:195], v250 offset:10496
    v_mfma_f32_16x16x32_bf16 v[164:167], v[228:231], v[104:107], v[164:167]
    v_mfma_f32_16x16x32_bf16 v[164:167], v[216:219], v[108:111], v[164:167]
    ds_read_b128 v[212:215], v253 offset:256
    v_mfma_f32_16x16x32_bf16 v[152:155], v[216:219], v[76:79], v[152:155]
    ds_read_b128 v[224:227], v253 offset:0
    v_mfma_f32_16x16x32_bf16 v[152:155], v[228:231], v[72:75], v[152:155]
    s_waitcnt lgkmcnt(3)
    buffer_load_dwordx4 v254, s[12:15], s21 offen offset:2048 nt lds
    v_mfma_f32_16x16x32_bf16 v[152:155], v[208:211], v[80:83], v[152:155]
    s_waitcnt lgkmcnt(2)
    ds_read_b128 v[220:223], v250 offset:8448
    v_mfma_f32_16x16x32_bf16 v[152:155], v[192:195], v[84:87], v[152:155]
    ds_read_b128 v[232:235], v250 offset:8192
    v_mfma_f32_16x16x32_bf16 v[164:167], v[192:195], v[116:119], v[164:167]
    ds_read_b128 v[216:219], v253 offset:8192
    v_mfma_f32_16x16x32_bf16 v[164:167], v[208:211], v[112:115], v[164:167]
    s_waitcnt lgkmcnt(3)
    ds_read_b128 v[228:231], v253 offset:8448
    v_mfma_f32_16x16x32_bf16 v[176:179], v[208:211], v[224:227], v[176:179]
    s_waitcnt lgkmcnt(5)
    v_mfma_f32_16x16x32_bf16 v[176:179], v[192:195], v[212:215], v[176:179]
    s_waitcnt lgkmcnt(3)
    v_mfma_f32_16x16x32_bf16 v[168:171], v[220:223], v[212:215], v[168:171]
    s_waitcnt lgkmcnt(2)
    ds_read_b128 v[212:215], v253 offset:16384
    v_mfma_f32_16x16x32_bf16 v[168:171], v[232:235], v[224:227], v[168:171]
    s_waitcnt lgkmcnt(2)
    ds_read_b128 v[224:227], v253 offset:16640
    v_mfma_f32_16x16x32_bf16 v[180:183], v[232:235], v[216:219], v[180:183]
    s_waitcnt lgkmcnt(2)
    v_mfma_f32_16x16x32_bf16 v[180:183], v[220:223], v[228:231], v[180:183]
    v_mfma_f32_16x16x32_bf16 v[188:191], v[192:195], v[228:231], v[188:191]
    v_mfma_f32_16x16x32_bf16 v[188:191], v[208:211], v[216:219], v[188:191]
    s_waitcnt lgkmcnt(1)
    buffer_load_dwordx4 v254, s[12:15], s21 offen offset:3072 nt lds
    v_mfma_f32_16x16x32_bf16 v[204:207], v[208:211], v[212:215], v[204:207]
    s_waitcnt lgkmcnt(0)
    v_mfma_f32_16x16x32_bf16 v[204:207], v[192:195], v[224:227], v[204:207]
    s_add_u32 s21, s21, 16384
    v_mfma_f32_16x16x32_bf16 v[196:199], v[220:223], v[224:227], v[196:199]
    ds_read_b128 v[208:211], v250 offset:8704
    v_mfma_f32_16x16x32_bf16 v[196:199], v[232:235], v[212:215], v[196:199]
    ds_read_b128 v[192:195], v250 offset:8960
    v_mfma_f32_16x16x32_bf16 v[156:159], v[232:235], v[112:115], v[156:159]
    v_mfma_f32_16x16x32_bf16 v[156:159], v[220:223], v[116:119], v[156:159]
    v_mfma_f32_16x16x32_bf16 v[144:147], v[220:223], v[84:87], v[144:147]
    ds_read_b128 v[228:231], v253 offset:512
    v_mfma_f32_16x16x32_bf16 v[144:147], v[232:235], v[80:83], v[144:147]
    s_waitcnt lgkmcnt(2)
    ds_read_b128 v[216:219], v253 offset:768
    v_mfma_f32_16x16x32_bf16 v[144:147], v[208:211], v[88:91], v[144:147]
    s_waitcnt lgkmcnt(2)
    ds_read_b128 v[224:227], v250 offset:11008
    v_mfma_f32_16x16x32_bf16 v[144:147], v[192:195], v[92:95], v[144:147]
    ds_read_b128 v[212:215], v250 offset:10752
    v_mfma_f32_16x16x32_bf16 v[156:159], v[192:195], v[124:127], v[156:159]
    ds_read_b128 v[220:223], v253 offset:8704
    v_mfma_f32_16x16x32_bf16 v[156:159], v[208:211], v[120:123], v[156:159]
    s_waitcnt lgkmcnt(4)
    ds_read_b128 v[232:235], v253 offset:8960
    v_mfma_f32_16x16x32_bf16 v[168:171], v[208:211], v[228:231], v[168:171]
    s_waitcnt lgkmcnt(4)
    buffer_load_dword v237, v236, s[92:95], s20 offen offset:0
    v_mfma_f32_16x16x32_bf16 v[168:171], v[192:195], v[216:219], v[168:171]
    s_waitcnt lgkmcnt(3)
    v_mfma_f32_16x16x32_bf16 v[176:179], v[224:227], v[216:219], v[176:179]
    s_waitcnt lgkmcnt(2)
    ds_read_b128 v[216:219], v253 offset:16896
    v_mfma_f32_16x16x32_bf16 v[176:179], v[212:215], v[228:231], v[176:179]
    s_waitcnt lgkmcnt(2)
    ds_read_b128 v[228:231], v253 offset:17152
    v_mfma_f32_16x16x32_bf16 v[188:191], v[212:215], v[220:223], v[188:191]
    s_waitcnt lgkmcnt(2)
    v_mfma_f32_16x16x32_bf16 v[188:191], v[224:227], v[232:235], v[188:191]
    v_mfma_f32_16x16x32_bf16 v[180:183], v[192:195], v[232:235], v[180:183]
    v_fma_f32 v144, v144, s26, v240
    v_fma_f32 v145, v145, s26, v240
    v_mfma_f32_16x16x32_bf16 v[180:183], v[208:211], v[220:223], v[180:183]
    s_waitcnt lgkmcnt(1)
    v_exp_f32 v144, v144
    v_mfma_f32_16x16x32_bf16 v[196:199], v[208:211], v[216:219], v[196:199]
    s_waitcnt lgkmcnt(0)
    v_exp_f32 v145, v145
    v_mfma_f32_16x16x32_bf16 v[196:199], v[192:195], v[228:231], v[196:199]
    ds_read_b64_tr_b16 v[208:209], v251 offset:16384
    v_add_f32 v245, v144, v245
    v_mfma_f32_16x16x32_bf16 v[204:207], v[224:227], v[228:231], v[204:207]
    ds_read_b64_tr_b16 v[210:211], v251 offset:18432
    v_cvt_pk_bf16_f32 v144, v144, v145
    v_mfma_f32_16x16x32_bf16 v[204:207], v[212:215], v[216:219], v[204:207]
    v_add_f32 v245, v145, v245
    v_fma_f32 v146, v146, s26, v240
    v_mfma_f32_16x16x32_bf16 v[164:167], v[212:215], v[120:123], v[164:167]
    v_exp_f32 v146, v146
    v_mfma_f32_16x16x32_bf16 v[164:167], v[224:227], v[124:127], v[164:167]
    v_fma_f32 v147, v147, s26, v240
    v_fma_f32 v156, v156, s26, v241
    v_mfma_f32_16x16x32_bf16 v[152:155], v[224:227], v[92:95], v[152:155]
    ds_read_b64_tr_b16 v[192:193], v252 offset:16384
    v_add_f32 v245, v146, v245
    v_mfma_f32_16x16x32_bf16 v[152:155], v[212:215], v[88:91], v[152:155]
    s_waitcnt lgkmcnt(1)
    ds_read_b64_tr_b16 v[194:195], v252 offset:18432
    v_fma_f32 v157, v157, s26, v241
    v_mfma_f32_16x16x32_bf16 v[0:3], v[208:211], v[148:151], v[0:3]
    v_exp_f32 v147, v147
    v_mfma_f32_16x16x32_bf16 a[0:3], v[208:211], v[160:163], a[0:3]
    v_exp_f32 v156, v156
    v_mfma_f32_16x16x32_bf16 a[64:67], v[208:211], v[172:175], a[64:67]
    v_exp_f32 v157, v157
    v_mfma_f32_16x16x32_bf16 a[128:131], v[208:211], v[184:187], a[128:131]
    ds_read_b64_tr_b16 v[232:233], v251 offset:16640
    v_cvt_pk_bf16_f32 v145, v146, v147
    v_mfma_f32_16x16x32_bf16 a[192:195], v[208:211], v[200:203], a[192:195]
    s_waitcnt lgkmcnt(1)
    ds_read_b64_tr_b16 v[234:235], v251 offset:18688
    v_add_f32 v245, v147, v245
    v_mfma_f32_16x16x32_bf16 a[196:199], v[192:195], v[200:203], a[196:199]
    v_fma_f32 v152, v152, s26, v240
    v_fma_f32 v153, v153, s26, v240
    v_mfma_f32_16x16x32_bf16 a[132:135], v[192:195], v[184:187], a[132:135]
    v_exp_f32 v152, v152
    v_mfma_f32_16x16x32_bf16 a[68:71], v[192:195], v[172:175], a[68:71]
    v_exp_f32 v153, v153
    v_mfma_f32_16x16x32_bf16 a[4:7], v[192:195], v[160:163], a[4:7]
    ds_read_b64_tr_b16 v[208:209], v252 offset:16640
    v_add_f32 v245, v152, v245
    v_mfma_f32_16x16x32_bf16 v[4:7], v[192:195], v[148:151], v[4:7]
    s_waitcnt lgkmcnt(1)
    ds_read_b64_tr_b16 v[210:211], v252 offset:18688
    v_cvt_pk_bf16_f32 v146, v152, v153
    v_mfma_f32_16x16x32_bf16 v[8:11], v[232:235], v[148:151], v[8:11]
    v_add_f32 v245, v153, v245
    v_fma_f32 v154, v154, s26, v240
    v_mfma_f32_16x16x32_bf16 a[8:11], v[232:235], v[160:163], a[8:11]
    v_exp_f32 v154, v154
    v_mfma_f32_16x16x32_bf16 a[72:75], v[232:235], v[172:175], a[72:75]
    v_fma_f32 v155, v155, s26, v240
    v_add_f32 v246, v156, v246
    v_mfma_f32_16x16x32_bf16 a[136:139], v[232:235], v[184:187], a[136:139]
    ds_read_b64_tr_b16 v[192:193], v251 offset:16896
    v_add_f32 v245, v154, v245
    v_mfma_f32_16x16x32_bf16 a[200:203], v[232:235], v[200:203], a[200:203]
    s_waitcnt lgkmcnt(1)
    ds_read_b64_tr_b16 v[194:195], v251 offset:18944
    v_cvt_pk_bf16_f32 v156, v156, v157
    v_mfma_f32_16x16x32_bf16 a[204:207], v[208:211], v[200:203], a[204:207]
    v_exp_f32 v155, v155
    v_mfma_f32_16x16x32_bf16 a[140:143], v[208:211], v[184:187], a[140:143]
    v_add_f32 v246, v157, v246
    v_fma_f32 v158, v158, s26, v241
    v_mfma_f32_16x16x32_bf16 a[76:79], v[208:211], v[172:175], a[76:79]
    v_exp_f32 v158, v158
    v_mfma_f32_16x16x32_bf16 a[12:15], v[208:211], v[160:163], a[12:15]
    ds_read_b64_tr_b16 v[220:221], v252 offset:16896
    v_cvt_pk_bf16_f32 v147, v154, v155
    v_mfma_f32_16x16x32_bf16 v[12:15], v[208:211], v[148:151], v[12:15]
    s_waitcnt lgkmcnt(1)
    ds_read_b64_tr_b16 v[222:223], v252 offset:18944
    v_add_f32 v245, v155, v245
    v_mfma_f32_16x16x32_bf16 v[16:19], v[192:195], v[148:151], v[16:19]
    v_add_f32 v246, v158, v246
    v_fma_f32 v159, v159, s26, v241
    v_mfma_f32_16x16x32_bf16 a[16:19], v[192:195], v[160:163], a[16:19]
    v_exp_f32 v159, v159
    v_mfma_f32_16x16x32_bf16 a[80:83], v[192:195], v[172:175], a[80:83]
    v_fma_f32 v164, v164, s26, v241
    v_fma_f32 v165, v165, s26, v241
    v_mfma_f32_16x16x32_bf16 a[144:147], v[192:195], v[184:187], a[144:147]
    ds_read_b64_tr_b16 v[208:209], v251 offset:17152
    v_cvt_pk_bf16_f32 v157, v158, v159
    v_mfma_f32_16x16x32_bf16 a[208:211], v[192:195], v[200:203], a[208:211]
    s_waitcnt lgkmcnt(1)
    ds_read_b64_tr_b16 v[210:211], v251 offset:19200
    v_add_f32 v246, v159, v246
    v_mfma_f32_16x16x32_bf16 a[212:215], v[220:223], v[200:203], a[212:215]
    v_exp_f32 v164, v164
    v_mfma_f32_16x16x32_bf16 a[148:151], v[220:223], v[184:187], a[148:151]
    v_exp_f32 v165, v165
    v_mfma_f32_16x16x32_bf16 a[84:87], v[220:223], v[172:175], a[84:87]
    v_add_f32 v246, v164, v246
    v_fma_f32 v166, v166, s26, v241
    v_mfma_f32_16x16x32_bf16 a[20:23], v[220:223], v[160:163], a[20:23]
    ds_read_b64_tr_b16 v[192:193], v252 offset:17152
    v_cvt_pk_bf16_f32 v158, v164, v165
    v_mfma_f32_16x16x32_bf16 v[20:23], v[220:223], v[148:151], v[20:23]
    s_waitcnt lgkmcnt(1)
    ds_read_b64_tr_b16 v[194:195], v252 offset:19200
    v_add_f32 v246, v165, v246
    v_mfma_f32_16x16x32_bf16 v[24:27], v[208:211], v[148:151], v[24:27]
    v_exp_f32 v166, v166
    v_mfma_f32_16x16x32_bf16 a[24:27], v[208:211], v[160:163], a[24:27]
    v_fma_f32 v167, v167, s26, v241
    v_fma_f32 v168, v168, s26, v242
    v_mfma_f32_16x16x32_bf16 a[88:91], v[208:211], v[172:175], a[88:91]
    v_exp_f32 v167, v167
    v_mfma_f32_16x16x32_bf16 a[152:155], v[208:211], v[184:187], a[152:155]
    ds_read_b64_tr_b16 v[228:229], v251 offset:24576
    v_add_f32 v246, v166, v246
    v_mfma_f32_16x16x32_bf16 a[216:219], v[208:211], v[200:203], a[216:219]
    s_waitcnt lgkmcnt(1)
    ds_read_b64_tr_b16 v[230:231], v251 offset:26624
    v_cvt_pk_bf16_f32 v159, v166, v167
    v_mfma_f32_16x16x32_bf16 a[220:223], v[192:195], v[200:203], a[220:223]
    v_exp_f32 v168, v168
    v_mfma_f32_16x16x32_bf16 a[156:159], v[192:195], v[184:187], a[156:159]
    v_add_f32 v246, v167, v246
    v_fma_f32 v169, v169, s26, v242
    v_mfma_f32_16x16x32_bf16 a[92:95], v[192:195], v[172:175], a[92:95]
    v_exp_f32 v169, v169
    v_mfma_f32_16x16x32_bf16 a[28:31], v[192:195], v[160:163], a[28:31]
    ds_read_b64_tr_b16 v[208:209], v252 offset:24576
    v_add_f32 v247, v168, v247
    v_mfma_f32_16x16x32_bf16 v[28:31], v[192:195], v[148:151], v[28:31]
    s_waitcnt lgkmcnt(1)
    ds_read_b64_tr_b16 v[210:211], v252 offset:26624
    v_cvt_pk_bf16_f32 v168, v168, v169
    v_mfma_f32_16x16x32_bf16 v[32:35], v[228:231], v[148:151], v[32:35]
    v_add_f32 v247, v169, v247
    v_fma_f32 v170, v170, s26, v242
    v_mfma_f32_16x16x32_bf16 a[32:35], v[228:231], v[160:163], a[32:35]
    v_exp_f32 v170, v170
    v_mfma_f32_16x16x32_bf16 a[96:99], v[228:231], v[172:175], a[96:99]
    v_fma_f32 v171, v171, s26, v242
    v_fma_f32 v176, v176, s26, v242
    v_mfma_f32_16x16x32_bf16 a[160:163], v[228:231], v[184:187], a[160:163]
    ds_read_b64_tr_b16 v[192:193], v251 offset:24832
    v_add_f32 v247, v170, v247
    v_mfma_f32_16x16x32_bf16 a[224:227], v[228:231], v[200:203], a[224:227]
    s_waitcnt lgkmcnt(1)
    ds_read_b64_tr_b16 v[194:195], v251 offset:26880
    v_fma_f32 v177, v177, s26, v242
    v_mfma_f32_16x16x32_bf16 a[228:231], v[208:211], v[200:203], a[228:231]
    v_exp_f32 v171, v171
    v_mfma_f32_16x16x32_bf16 a[164:167], v[208:211], v[184:187], a[164:167]
    v_exp_f32 v176, v176
    v_mfma_f32_16x16x32_bf16 a[100:103], v[208:211], v[172:175], a[100:103]
    v_exp_f32 v177, v177
    v_mfma_f32_16x16x32_bf16 a[36:39], v[208:211], v[160:163], a[36:39]
    ds_read_b64_tr_b16 v[216:217], v252 offset:24832
    v_cvt_pk_bf16_f32 v169, v170, v171
    v_mfma_f32_16x16x32_bf16 v[36:39], v[208:211], v[148:151], v[36:39]
    s_waitcnt lgkmcnt(1)
    ds_read_b64_tr_b16 v[218:219], v252 offset:26880
    v_cvt_pk_bf16_f32 v170, v176, v177
    v_mfma_f32_16x16x32_bf16 v[40:43], v[192:195], v[148:151], v[40:43]
    v_add_f32 v247, v171, v247
    v_add_f32 v247, v176, v247
    v_mfma_f32_16x16x32_bf16 a[40:43], v[192:195], v[160:163], a[40:43]
    v_add_f32 v247, v177, v247
    v_fma_f32 v178, v178, s26, v242
    v_mfma_f32_16x16x32_bf16 a[104:107], v[192:195], v[172:175], a[104:107]
    v_exp_f32 v178, v178
    v_mfma_f32_16x16x32_bf16 a[168:171], v[192:195], v[184:187], a[168:171]
    ds_read_b64_tr_b16 v[208:209], v251 offset:25088
    v_fma_f32 v179, v179, s26, v242
    v_mfma_f32_16x16x32_bf16 a[232:235], v[192:195], v[200:203], a[232:235]
    s_waitcnt lgkmcnt(1)
    ds_read_b64_tr_b16 v[210:211], v251 offset:27136
    v_add_f32 v247, v178, v247
    v_mfma_f32_16x16x32_bf16 a[236:239], v[216:219], v[200:203], a[236:239]
    v_exp_f32 v179, v179
    v_mfma_f32_16x16x32_bf16 a[172:175], v[216:219], v[184:187], a[172:175]
    ds_read_b64_tr_b16 v[192:193], v252 offset:25088
    v_fma_f32 v180, v180, s26, v243
    v_mfma_f32_16x16x32_bf16 a[108:111], v[216:219], v[172:175], a[108:111]
    ds_read_b64_tr_b16 v[194:195], v252 offset:27136
    v_cvt_pk_bf16_f32 v171, v178, v179
    v_mfma_f32_16x16x32_bf16 a[44:47], v[216:219], v[160:163], a[44:47]
    ds_read_b64_tr_b16 v[224:225], v251 offset:25344
    v_add_f32 v247, v179, v247
    v_mfma_f32_16x16x32_bf16 v[44:47], v[216:219], v[148:151], v[44:47]
    s_waitcnt lgkmcnt(3)
    ds_read_b64_tr_b16 v[226:227], v251 offset:27392
    v_fma_f32 v181, v181, s26, v243
    v_mfma_f32_16x16x32_bf16 v[48:51], v[208:211], v[148:151], v[48:51]
    ds_read_b64_tr_b16 v[232:233], v252 offset:25344
    v_fma_f32 v182, v182, s26, v243
    v_mfma_f32_16x16x32_bf16 a[48:51], v[208:211], v[160:163], a[48:51]
    ds_read_b64_tr_b16 v[234:235], v252 offset:27392
    v_fma_f32 v183, v183, s26, v243
    v_mfma_f32_16x16x32_bf16 a[112:115], v[208:211], v[172:175], a[112:115]
    v_exp_f32 v180, v180
    v_mfma_f32_16x16x32_bf16 a[176:179], v[208:211], v[184:187], a[176:179]
    v_exp_f32 v181, v181
    v_mfma_f32_16x16x32_bf16 a[240:243], v[208:211], v[200:203], a[240:243]
    s_waitcnt lgkmcnt(4)
    v_exp_f32 v182, v182
    v_mfma_f32_16x16x32_bf16 a[244:247], v[192:195], v[200:203], a[244:247]
    v_exp_f32 v183, v183
    v_mfma_f32_16x16x32_bf16 a[180:183], v[192:195], v[184:187], a[180:183]
    s_waitcnt vmcnt(1) lgkmcnt(0)
    s_barrier
    v_mfma_f32_16x16x32_bf16 a[116:119], v[192:195], v[172:175], a[116:119]
    v_add_f32 v248, v180, v248
    v_cvt_pk_bf16_f32 v180, v180, v181
    v_mfma_f32_16x16x32_bf16 a[52:55], v[192:195], v[160:163], a[52:55]
    v_add_f32 v248, v181, v248
    v_cvt_pk_bf16_f32 v181, v182, v183
    v_mfma_f32_16x16x32_bf16 v[52:55], v[192:195], v[148:151], v[52:55]
    v_add_f32 v248, v182, v248
    v_add_f32 v248, v183, v248
    v_mfma_f32_16x16x32_bf16 v[56:59], v[224:227], v[148:151], v[56:59]
    s_sub_u32 s27, s27, 1
    v_fma_f32 v188, v188, s26, v243
    v_fma_f32 v189, v189, s26, v243
    v_mfma_f32_16x16x32_bf16 a[56:59], v[224:227], v[160:163], a[56:59]
    v_exp_f32 v188, v188
    v_mfma_f32_16x16x32_bf16 a[120:123], v[224:227], v[172:175], a[120:123]
    v_exp_f32 v189, v189
    v_mfma_f32_16x16x32_bf16 a[184:187], v[224:227], v[184:187], a[184:187]
    v_add_f32 v248, v188, v248
    v_fma_f32 v190, v190, s26, v243
    v_mfma_f32_16x16x32_bf16 a[248:251], v[224:227], v[200:203], a[248:251]
    ds_read_b128 v[212:215], v250 offset:18432
    v_cvt_pk_bf16_f32 v182, v188, v189
    v_mfma_f32_16x16x32_bf16 a[252:255], v[232:235], v[200:203], a[252:255]
    ds_read_b128 v[216:219], v250 offset:18688
    v_add_f32 v248, v189, v248
    v_mfma_f32_16x16x32_bf16 a[188:191], v[232:235], v[184:187], a[188:191]
    v_exp_f32 v190, v190
    v_mfma_f32_16x16x32_bf16 a[124:127], v[232:235], v[172:175], a[124:127]
    v_fma_f32 v191, v191, s26, v243
    v_fma_f32 v196, v196, s26, v244
    v_mfma_f32_16x16x32_bf16 a[60:63], v[232:235], v[160:163], a[60:63]
    s_cmp_lg_u32 s27, 0
    ds_read_b128 v[220:223], v253 offset:4096
    v_add_f32 v248, v190, v248
    v_mfma_f32_16x16x32_bf16 v[60:63], v[232:235], v[148:151], v[60:63]
    s_waitcnt lgkmcnt(2)
    ds_read_b128 v[224:227], v253 offset:4352
    v_fma_f32 v197, v197, s26, v244
    s_cbranch_scc1 L_loop
L_endphase:
    s_waitcnt vmcnt(0) lgkmcnt(0)
    ds_read_b128 v[212:215], v250 offset:16384
    ds_read_b128 v[216:219], v250 offset:18432
    ds_read_b128 v[220:223], v250 offset:16640
    ds_read_b128 v[224:227], v250 offset:18688
    ds_read_b128 v[228:231], v250 offset:16896
    ds_read_b128 v[232:235], v250 offset:18944
    v_exp_f32 v191, v191
    ds_read_b128 v[236:239], v250 offset:17152
    v_cvt_pk_bf16_f32 v183, v190, v191
    v_add_f32 v248, v191, v248
    v_fma_f32 v198, v198, s26, v244
    v_fma_f32 v199, v199, s26, v244
    v_fma_f32 v204, v204, s26, v244
    v_fma_f32 v205, v205, s26, v244
    v_fma_f32 v206, v206, s26, v244
    v_fma_f32 v207, v207, s26, v244
    v_exp_f32 v196, v196
    v_exp_f32 v197, v197
    s_waitcnt lgkmcnt(6)
    v_mfma_f32_16x16x32_bf16 v[148:151], v[212:215], v[64:67], 0
    s_waitcnt lgkmcnt(5)
    ds_read_b128 v[212:215], v250 offset:19200
    v_exp_f32 v198, v198
    v_mfma_f32_16x16x32_bf16 v[152:155], v[216:219], v[64:67], 0
    s_waitcnt lgkmcnt(5)
    ds_read_b128 v[216:219], v250 offset:24576
    v_exp_f32 v199, v199
    v_mfma_f32_16x16x32_bf16 v[148:151], v[220:223], v[68:71], v[148:151]
    s_waitcnt lgkmcnt(5)
    ds_read_b128 v[220:223], v250 offset:26624
    v_exp_f32 v204, v204
    v_mfma_f32_16x16x32_bf16 v[152:155], v[224:227], v[68:71], v[152:155]
    s_waitcnt lgkmcnt(5)
    ds_read_b128 v[224:227], v250 offset:24832
    v_exp_f32 v205, v205
    v_mfma_f32_16x16x32_bf16 v[148:151], v[228:231], v[72:75], v[148:151]
    s_waitcnt lgkmcnt(5)
    ds_read_b128 v[228:231], v250 offset:26880
    v_exp_f32 v206, v206
    v_mfma_f32_16x16x32_bf16 v[152:155], v[232:235], v[72:75], v[152:155]
    s_waitcnt lgkmcnt(5)
    ds_read_b128 v[232:235], v250 offset:25088
    s_lshl_b32 s30, s29, 12
    v_mfma_f32_16x16x32_bf16 v[148:151], v[236:239], v[76:79], v[148:151]
    s_waitcnt lgkmcnt(5)
    ds_read_b128 v[236:239], v250 offset:27136
    v_and_b32 v72, 15, v255
    v_mfma_f32_16x16x32_bf16 v[152:155], v[212:215], v[76:79], v[152:155]
    s_waitcnt lgkmcnt(5)
    ds_read_b128 v[212:215], v250 offset:25344
    v_lshlrev_b32 v72, 8, v72
    v_mfma_f32_16x16x32_bf16 v[148:151], v[216:219], v[80:83], v[148:151]
    s_waitcnt lgkmcnt(5)
    ds_read_b128 v[216:219], v250 offset:27392
    v_add_u32 v72, s30, v72
    v_mfma_f32_16x16x32_bf16 v[152:155], v[220:223], v[80:83], v[152:155]
    s_waitcnt lgkmcnt(5)
    ds_read_b64_tr_b16 v[220:221], v251 offset:32768
    ds_read_b64_tr_b16 v[222:223], v251 offset:34816
    v_mfma_f32_16x16x32_bf16 v[148:151], v[224:227], v[84:87], v[148:151]
    s_waitcnt lgkmcnt(6)
    ds_read_b64_tr_b16 v[224:225], v252 offset:32768
    ds_read_b64_tr_b16 v[226:227], v252 offset:34816
    v_mfma_f32_16x16x32_bf16 v[152:155], v[228:231], v[84:87], v[152:155]
    s_waitcnt lgkmcnt(7)
    ds_read_b64_tr_b16 v[228:229], v251 offset:33024
    ds_read_b64_tr_b16 v[230:231], v251 offset:35072
    v_mfma_f32_16x16x32_bf16 v[148:151], v[232:235], v[88:91], v[148:151]
    s_waitcnt lgkmcnt(8)
    ds_read_b64_tr_b16 v[232:233], v252 offset:33024
    ds_read_b64_tr_b16 v[234:235], v252 offset:35072
    v_mfma_f32_16x16x32_bf16 v[152:155], v[236:239], v[88:91], v[152:155]
    s_waitcnt lgkmcnt(9)
    ds_read_b64_tr_b16 v[236:237], v251 offset:33280
    ds_read_b64_tr_b16 v[238:239], v251 offset:35328
    v_mfma_f32_16x16x32_bf16 v[148:151], v[212:215], v[92:95], v[148:151]
    s_waitcnt lgkmcnt(10)
    ds_read_b64_tr_b16 v[212:213], v252 offset:33280
    ds_read_b64_tr_b16 v[214:215], v252 offset:35328
    v_mfma_f32_16x16x32_bf16 v[152:155], v[216:219], v[92:95], v[152:155]
    ds_read_b64_tr_b16 v[216:217], v251 offset:33536
    ds_read_b64_tr_b16 v[218:219], v251 offset:35584
    ds_read_b64_tr_b16 v[92:93], v252 offset:33536
    ds_read_b64_tr_b16 v[94:95], v252 offset:35584
    s_waitcnt lgkmcnt(14)
    v_mfma_f32_16x16x32_bf16 v[0:3], v[220:223], v[144:147], v[0:3]
    ds_read_b64_tr_b16 v[220:221], v251 offset:40960
    ds_read_b64_tr_b16 v[222:223], v251 offset:43008
    v_lshrrev_b32 v73, 5, v255
    v_and_b32 v68, 7, v255
    v_xor_b32 v73, v73, v68
    v_lshl_add_u32 v72, v73, 4, v72
    v_bfe_u32 v73, v255, 4, 1
    v_lshl_add_u32 v68, v73, 3, v72
    v_xor_b32 v69, 32, v68
    v_xor_b32 v70, 64, v68
    v_xor_b32 v71, 96, v68
    v_bfe_u32 v73, v255, 4, 1
    v_and_b32 v72, 15, v255
    v_xor_b32 v72, v72, v73
    v_lshlrev_b32 v72, 4, v72
    v_lshl_add_u32 v72, v73, 8, v72
    v_lshrrev_b32 v73, 5, v255
    v_lshl_add_u32 v72, v73, 11, v72
    v_add_u32 v64, s30, v72
    v_xor_b32 v65, 32, v64
    v_xor_b32 v66, 64, v64
    v_xor_b32 v67, 96, v64
    v_bfe_u32 v72, v255, 4, 1
    v_lshrrev_b32 v73, 5, v255
    v_lshl_add_u32 v72, v73, 3, v72
    v_add_u32 v72, s40, v72
    v_lshlrev_b32 v72, 9, v72
    v_and_b32 v73, 15, v255
    v_lshl_add_u32 v254, v73, 4, v72
    s_waitcnt lgkmcnt(14)
    v_mfma_f32_16x16x32_bf16 v[4:7], v[224:227], v[144:147], v[4:7]
    s_waitcnt lgkmcnt(12)
    ds_read_b64_tr_b16 v[224:225], v251 offset:0
    ds_read_b64_tr_b16 v[226:227], v251 offset:2048
    v_mfma_f32_16x16x32_bf16 v[8:11], v[228:231], v[144:147], v[8:11]
    s_waitcnt lgkmcnt(12)
    ds_read_b64_tr_b16 v[228:229], v252 offset:40960
    ds_read_b64_tr_b16 v[230:231], v252 offset:43008
    v_mfma_f32_16x16x32_bf16 v[12:15], v[232:235], v[144:147], v[12:15]
    s_waitcnt lgkmcnt(12)
    ds_read_b64_tr_b16 v[232:233], v252 offset:0
    ds_read_b64_tr_b16 v[234:235], v252 offset:2048
    v_mfma_f32_16x16x32_bf16 v[16:19], v[236:239], v[144:147], v[16:19]
    s_waitcnt lgkmcnt(12)
    ds_read_b64_tr_b16 v[236:237], v251 offset:41216
    ds_read_b64_tr_b16 v[238:239], v251 offset:43264
    v_mfma_f32_16x16x32_bf16 v[20:23], v[212:215], v[144:147], v[20:23]
    s_waitcnt lgkmcnt(12)
    ds_read_b64_tr_b16 v[212:213], v251 offset:256
    ds_read_b64_tr_b16 v[214:215], v251 offset:2304
    v_mfma_f32_16x16x32_bf16 v[24:27], v[216:219], v[144:147], v[24:27]
    s_waitcnt lgkmcnt(12)
    ds_read_b64_tr_b16 v[216:217], v252 offset:41216
    ds_read_b64_tr_b16 v[218:219], v252 offset:43264
    v_mfma_f32_16x16x32_bf16 v[28:31], v[92:95], v[144:147], v[28:31]
    s_waitcnt lgkmcnt(12)
    ds_read_b64_tr_b16 v[92:93], v252 offset:256
    ds_read_b64_tr_b16 v[94:95], v252 offset:2304
    v_mfma_f32_16x16x32_bf16 v[32:35], v[220:223], v[144:147], v[32:35]
    ds_read_b64_tr_b16 v[220:221], v251 offset:41472
    ds_read_b64_tr_b16 v[222:223], v251 offset:43520
    v_fma_f32 v148, v148, s26, v240
    v_fma_f32 v149, v149, s26, v240
    v_fma_f32 v150, v150, s26, v240
    v_fma_f32 v151, v151, s26, v240
    v_fma_f32 v152, v152, s26, v240
    v_fma_f32 v153, v153, s26, v240
    v_fma_f32 v154, v154, s26, v240
    v_fma_f32 v155, v155, s26, v240
    v_exp_f32 v148, v148
    v_exp_f32 v149, v149
    v_exp_f32 v150, v150
    v_exp_f32 v151, v151
    v_exp_f32 v152, v152
    v_exp_f32 v153, v153
    v_exp_f32 v154, v154
    v_exp_f32 v155, v155
    v_add_f32 v245, v148, v245
    v_add_f32 v245, v149, v245
    v_add_f32 v245, v150, v245
    v_add_f32 v245, v151, v245
    v_cvt_pk_bf16_f32 v148, v148, v149
    v_cvt_pk_bf16_f32 v149, v150, v151
    v_cvt_pk_bf16_f32 v150, v152, v153
    v_cvt_pk_bf16_f32 v151, v154, v155
    v_add_f32 v245, v152, v245
    v_add_f32 v245, v153, v245
    s_waitcnt lgkmcnt(14)
    v_mfma_f32_16x16x32_bf16 v[0:3], v[224:227], v[148:151], v[0:3]
    s_waitcnt lgkmcnt(12)
    ds_read_b64_tr_b16 v[224:225], v251 offset:512
    ds_read_b64_tr_b16 v[226:227], v251 offset:2560
    v_mfma_f32_16x16x32_bf16 v[36:39], v[228:231], v[144:147], v[36:39]
    ds_read_b64_tr_b16 v[228:229], v252 offset:41472
    ds_read_b64_tr_b16 v[230:231], v252 offset:43520
    v_add_f32 v245, v154, v245
    v_add_f32 v245, v155, v245
    v_mov_b32 v152, v245
    s_waitcnt lgkmcnt(14)
    v_mfma_f32_16x16x32_bf16 v[4:7], v[232:235], v[148:151], v[4:7]
    ds_read_b64_tr_b16 v[232:233], v252 offset:512
    ds_read_b64_tr_b16 v[234:235], v252 offset:2560
    v_permlane32_swap_b32 v245, v152
    v_add_f32 v245, v245, v152
    v_mov_b32 v152, v245
    s_waitcnt lgkmcnt(14)
    v_mfma_f32_16x16x32_bf16 v[40:43], v[236:239], v[144:147], v[40:43]
    ds_read_b64_tr_b16 v[236:237], v251 offset:41728
    ds_read_b64_tr_b16 v[238:239], v251 offset:43776
    v_permlane16_swap_b32 v245, v152
    v_add_f32 v245, v245, v152
    v_mov_b32 v240, v245
    v_rcp_f32 v152, v245
    s_waitcnt lgkmcnt(14)
    v_mfma_f32_16x16x32_bf16 v[8:11], v[212:215], v[148:151], v[8:11]
    ds_read_b64_tr_b16 v[212:213], v251 offset:768
    ds_read_b64_tr_b16 v[214:215], v251 offset:2816
    v_mov_b32 v153, v152
    v_pk_mul_f32 v[0:1], v[0:1], v[152:153]
    v_pk_mul_f32 v[2:3], v[2:3], v[152:153]
    v_cvt_pk_bf16_f32 v0, v0, v1
    v_cvt_pk_bf16_f32 v1, v2, v3
    s_waitcnt lgkmcnt(14)
    v_mfma_f32_16x16x32_bf16 v[44:47], v[216:219], v[144:147], v[44:47]
    s_waitcnt lgkmcnt(12)
    ds_read_b64_tr_b16 v[216:217], v252 offset:41728
    ds_read_b64_tr_b16 v[218:219], v252 offset:43776
    ds_write_b64 v68, v[0:1] offset:0
    v_mfma_f32_16x16x32_bf16 v[12:15], v[92:95], v[148:151], v[12:15]
    ds_read_b64_tr_b16 v[92:93], v252 offset:768
    ds_read_b64_tr_b16 v[94:95], v252 offset:2816
    v_exp_f32 v207, v207
    v_pk_mul_f32 v[4:5], v[4:5], v[152:153]
    v_pk_mul_f32 v[6:7], v[6:7], v[152:153]
    v_cvt_pk_bf16_f32 v4, v4, v5
    v_cvt_pk_bf16_f32 v5, v6, v7
    s_waitcnt lgkmcnt(15)
    v_mfma_f32_16x16x32_bf16 v[48:51], v[220:223], v[144:147], v[48:51]
    s_waitcnt lgkmcnt(13)
    ds_read_b64_tr_b16 v[220:221], v251 offset:8192
    ds_read_b64_tr_b16 v[222:223], v251 offset:10240
    ds_write_b64 v69, v[4:5] offset:0
    v_mfma_f32_16x16x32_bf16 v[16:19], v[224:227], v[148:151], v[16:19]
    ds_read_b64_tr_b16 v[224:225], v252 offset:8192
    ds_read_b64_tr_b16 v[226:227], v252 offset:10240
    v_add_f32 v249, v196, v249
    v_pk_mul_f32 v[8:9], v[8:9], v[152:153]
    v_pk_mul_f32 v[10:11], v[10:11], v[152:153]
    v_cvt_pk_bf16_f32 v8, v8, v9
    v_cvt_pk_bf16_f32 v9, v10, v11
    s_waitcnt lgkmcnt(15)
    v_mfma_f32_16x16x32_bf16 v[52:55], v[228:231], v[144:147], v[52:55]
    s_waitcnt lgkmcnt(14)
    ds_read_b64_tr_b16 v[228:229], v251 offset:8448
    ds_read_b64_tr_b16 v[230:231], v251 offset:10496
    ds_write_b64 v70, v[8:9] offset:0
    v_mfma_f32_16x16x32_bf16 v[20:23], v[232:235], v[148:151], v[20:23]
    ds_read_b64_tr_b16 v[232:233], v252 offset:8448
    ds_read_b64_tr_b16 v[234:235], v252 offset:10496
    v_add_f32 v249, v197, v249
    v_pk_mul_f32 v[12:13], v[12:13], v[152:153]
    v_pk_mul_f32 v[14:15], v[14:15], v[152:153]
    v_cvt_pk_bf16_f32 v12, v12, v13
    v_cvt_pk_bf16_f32 v13, v14, v15
    s_waitcnt lgkmcnt(15)
    v_mfma_f32_16x16x32_bf16 v[56:59], v[236:239], v[144:147], v[56:59]
    ds_read_b64_tr_b16 v[236:237], v251 offset:8704
    ds_read_b64_tr_b16 v[238:239], v251 offset:10752
    ds_write_b64 v71, v[12:13] offset:0
    v_mfma_f32_16x16x32_bf16 v[24:27], v[212:215], v[148:151], v[24:27]
    ds_read_b64_tr_b16 v[212:213], v252 offset:8704
    ds_read_b64_tr_b16 v[214:215], v252 offset:10752
    v_add_f32 v249, v198, v249
    v_pk_mul_f32 v[16:17], v[16:17], v[152:153]
    v_pk_mul_f32 v[18:19], v[18:19], v[152:153]
    v_cvt_pk_bf16_f32 v16, v16, v17
    v_cvt_pk_bf16_f32 v17, v18, v19
    s_waitcnt lgkmcnt(15)
    v_mfma_f32_16x16x32_bf16 v[60:63], v[216:219], v[144:147], v[60:63]
    ds_read_b64_tr_b16 v[216:217], v251 offset:8960
    ds_read_b64_tr_b16 v[218:219], v251 offset:11008
    ds_write_b64 v68, v[16:17] offset:128
    v_mfma_f32_16x16x32_bf16 v[28:31], v[92:95], v[148:151], v[28:31]
    ds_read_b64_tr_b16 v[92:93], v252 offset:8960
    ds_read_b64_tr_b16 v[94:95], v252 offset:11008
    v_add_f32 v249, v199, v249
    v_pk_mul_f32 v[20:21], v[20:21], v[152:153]
    v_pk_mul_f32 v[22:23], v[22:23], v[152:153]
    v_cvt_pk_bf16_f32 v20, v20, v21
    v_cvt_pk_bf16_f32 v21, v22, v23
    s_waitcnt lgkmcnt(15)
    v_mfma_f32_16x16x32_bf16 v[32:35], v[220:223], v[148:151], v[32:35]
    ds_read_b128 v[220:223], v250 offset:16384
    ds_write_b64 v69, v[20:21] offset:128
    v_mfma_f32_16x16x32_bf16 v[36:39], v[224:227], v[148:151], v[36:39]
    ds_read_b128 v[224:227], v250 offset:18432
    v_cvt_pk_bf16_f32 v196, v196, v197
    v_cvt_pk_bf16_f32 v197, v198, v199
    v_cvt_pk_bf16_f32 v198, v204, v205
    v_pk_mul_f32 v[24:25], v[24:25], v[152:153]
    v_pk_mul_f32 v[26:27], v[26:27], v[152:153]
    v_cvt_pk_bf16_f32 v24, v24, v25
    v_cvt_pk_bf16_f32 v25, v26, v27
    s_waitcnt lgkmcnt(15)
    v_mfma_f32_16x16x32_bf16 v[40:43], v[228:231], v[148:151], v[40:43]
    s_waitcnt lgkmcnt(13)
    ds_write_b64 v70, v[24:25] offset:128
    ds_read_b128 v[228:231], v250 offset:16640
    v_mfma_f32_16x16x32_bf16 v[44:47], v[232:235], v[148:151], v[44:47]
    ds_read_b128 v[232:235], v250 offset:18688
    v_cvt_pk_bf16_f32 v199, v206, v207
    v_add_f32 v249, v204, v249
    v_add_f32 v249, v205, v249
    v_pk_mul_f32 v[28:29], v[28:29], v[152:153]
    v_pk_mul_f32 v[30:31], v[30:31], v[152:153]
    v_cvt_pk_bf16_f32 v28, v28, v29
    v_cvt_pk_bf16_f32 v29, v30, v31
    s_waitcnt lgkmcnt(14)
    v_mfma_f32_16x16x32_bf16 v[48:51], v[236:239], v[148:151], v[48:51]
    ds_write_b64 v71, v[28:29] offset:128
    ds_read_b128 v[76:79], v64 offset:0
    ds_read_b128 v[80:83], v65 offset:512
    ds_read_b128 v[84:87], v66 offset:1024
    ds_read_b128 v[88:91], v67 offset:1536
    v_pk_mul_f32 v[32:33], v[32:33], v[152:153]
    v_pk_mul_f32 v[34:35], v[34:35], v[152:153]
    v_cvt_pk_bf16_f32 v32, v32, v33
    v_cvt_pk_bf16_f32 v33, v34, v35
    s_waitcnt lgkmcnt(15)
    v_mfma_f32_16x16x32_bf16 v[52:55], v[212:215], v[148:151], v[52:55]
    ds_write_b64 v68, v[32:33] offset:49152
    v_add_f32 v249, v206, v249
    v_add_f32 v249, v207, v249
    ds_read_b128 v[236:239], v250 offset:16896
    v_pk_mul_f32 v[36:37], v[36:37], v[152:153]
    v_pk_mul_f32 v[38:39], v[38:39], v[152:153]
    v_cvt_pk_bf16_f32 v36, v36, v37
    v_cvt_pk_bf16_f32 v37, v38, v39
    s_waitcnt lgkmcnt(15)
    v_mfma_f32_16x16x32_bf16 v[56:59], v[216:219], v[148:151], v[56:59]
    s_waitcnt lgkmcnt(13)
    ds_write_b64 v69, v[36:37] offset:49152
    ds_read_b128 v[212:215], v250 offset:18944
    v_mfma_f32_16x16x32_bf16 v[60:63], v[92:95], v[148:151], v[60:63]
    s_waitcnt lgkmcnt(7)
    buffer_store_dwordx4 v[76:79], v254, s[16:19], s54 offen offset:0 nt
    s_waitcnt lgkmcnt(6)
    buffer_store_dwordx4 v[80:83], v254, s[16:19], s54 offen offset:1024 nt
    s_waitcnt lgkmcnt(5)
    buffer_store_dwordx4 v[84:87], v254, s[16:19], s54 offen offset:2048 nt
    s_waitcnt lgkmcnt(4)
    buffer_store_dwordx4 v[88:91], v254, s[16:19], s54 offen offset:3072 nt
    v_pk_mul_f32 v[40:41], v[40:41], v[152:153]
    v_pk_mul_f32 v[42:43], v[42:43], v[152:153]
    v_cvt_pk_bf16_f32 v40, v40, v41
    v_cvt_pk_bf16_f32 v41, v42, v43
    v_pk_mul_f32 v[44:45], v[44:45], v[152:153]
    v_pk_mul_f32 v[46:47], v[46:47], v[152:153]
    v_cvt_pk_bf16_f32 v44, v44, v45
    v_cvt_pk_bf16_f32 v45, v46, v47
    v_mfma_f32_16x16x32_bf16 v[160:163], v[220:223], v[96:99], 0
    ds_write_b64 v70, v[40:41] offset:49152
    ds_write_b64 v71, v[44:45] offset:49152
    ds_read_b128 v[216:219], v250 offset:17152
    v_pk_mul_f32 v[48:49], v[48:49], v[152:153]
    v_pk_mul_f32 v[50:51], v[50:51], v[152:153]
    v_cvt_pk_bf16_f32 v48, v48, v49
    v_cvt_pk_bf16_f32 v49, v50, v51
    v_mfma_f32_16x16x32_bf16 v[172:175], v[220:223], v[128:131], 0
    ds_write_b64 v68, v[48:49] offset:49280
    ds_read_b128 v[92:95], v250 offset:19200
    v_mfma_f32_16x16x32_bf16 v[176:179], v[224:227], v[128:131], 0
    ds_read_b128 v[220:223], v250 offset:24576
    v_mfma_f32_16x16x32_bf16 v[164:167], v[224:227], v[96:99], 0
    ds_read_b128 v[224:227], v253 offset:0
    v_mfma_f32_16x16x32_bf16 v[160:163], v[228:231], v[100:103], v[160:163]
    ds_read_b64_tr_b16 v[128:129], v251 offset:32768
    v_mfma_f32_16x16x32_bf16 v[172:175], v[228:231], v[132:135], v[172:175]
    ds_read_b128 v[228:231], v250 offset:26624
    v_mfma_f32_16x16x32_bf16 v[176:179], v[232:235], v[132:135], v[176:179]
    ds_read_b64_tr_b16 v[130:131], v251 offset:34816
    ds_read_b64_tr_b16 v[96:97], v252 offset:32768
    ds_read_b64_tr_b16 v[98:99], v252 offset:34816
    v_pk_mul_f32 v[52:53], v[52:53], v[152:153]
    v_pk_mul_f32 v[54:55], v[54:55], v[152:153]
    v_cvt_pk_bf16_f32 v52, v52, v53
    v_cvt_pk_bf16_f32 v53, v54, v55
    v_pk_mul_f32 v[56:57], v[56:57], v[152:153]
    v_pk_mul_f32 v[58:59], v[58:59], v[152:153]
    v_cvt_pk_bf16_f32 v56, v56, v57
    v_cvt_pk_bf16_f32 v57, v58, v59
    v_pk_mul_f32 v[60:61], v[60:61], v[152:153]
    v_pk_mul_f32 v[62:63], v[62:63], v[152:153]
    v_cvt_pk_bf16_f32 v60, v60, v61
    v_cvt_pk_bf16_f32 v61, v62, v63
    v_mfma_f32_16x16x32_bf16 v[164:167], v[232:235], v[100:103], v[164:167]
    s_waitcnt lgkmcnt(14)
    ds_write_b64 v69, v[52:53] offset:49280
    ds_write_b64 v70, v[56:57] offset:49280
    ds_write_b64 v71, v[60:61] offset:49280
    v_mfma_f32_16x16x32_bf16 v[160:163], v[236:239], v[104:107], v[160:163]
    ds_read_b128 v[76:79], v64 offset:49152
    v_mfma_f32_16x16x32_bf16 v[172:175], v[236:239], v[136:139], v[172:175]
    s_waitcnt lgkmcnt(15)
    ds_read_b128 v[80:83], v65 offset:49664
    v_mfma_f32_16x16x32_bf16 v[176:179], v[212:215], v[136:139], v[176:179]
    ds_read_b128 v[84:87], v66 offset:50176
    v_mfma_f32_16x16x32_bf16 v[164:167], v[212:215], v[104:107], v[164:167]
    s_waitcnt lgkmcnt(15)
    ds_read_b128 v[88:91], v67 offset:50688
    v_mfma_f32_16x16x32_bf16 v[160:163], v[216:219], v[108:111], v[160:163]
    ds_read_b128 v[232:235], v250 offset:24832
    v_mfma_f32_16x16x32_bf16 v[172:175], v[216:219], v[140:143], v[172:175]
    s_waitcnt lgkmcnt(15)
    ds_read_b128 v[236:239], v253 offset:256
    v_mfma_f32_16x16x32_bf16 v[176:179], v[92:95], v[140:143], v[176:179]
    ds_read_b128 v[212:215], v250 offset:26880
    v_mfma_f32_16x16x32_bf16 v[164:167], v[92:95], v[108:111], v[164:167]
    s_waitcnt lgkmcnt(15)
    ds_read_b128 v[216:219], v250 offset:25088
    v_mfma_f32_16x16x32_bf16 v[160:163], v[220:223], v[112:115], v[160:163]
    ds_read_b128 v[92:95], v253 offset:512
    v_mfma_f32_16x16x32_bf16 v[172:175], v[220:223], v[224:227], v[172:175]
    s_waitcnt lgkmcnt(8)
    buffer_store_dwordx4 v[76:79], v254, s[16:19], s54 offen offset:256 nt
    s_waitcnt lgkmcnt(7)
    buffer_store_dwordx4 v[80:83], v254, s[16:19], s54 offen offset:1280 nt
    s_waitcnt lgkmcnt(6)
    buffer_store_dwordx4 v[84:87], v254, s[16:19], s54 offen offset:2304 nt
    s_waitcnt lgkmcnt(5)
    buffer_store_dwordx4 v[88:91], v254, s[16:19], s54 offen offset:3328 nt
    ds_read_b128 v[220:223], v250 offset:27136
    v_mfma_f32_16x16x32_bf16 v[176:179], v[228:231], v[224:227], v[176:179]
    ds_read_b128 v[224:227], v250 offset:25344
    ds_read_b64_tr_b16 v[132:133], v251 offset:33024
    v_mfma_f32_16x16x32_bf16 v[164:167], v[228:231], v[112:115], v[164:167]
    s_waitcnt lgkmcnt(7)
    ds_read_b128 v[228:231], v253 offset:768
    ds_read_b64_tr_b16 v[134:135], v251 offset:35072
    v_mfma_f32_16x16x32_bf16 v[160:163], v[232:235], v[116:119], v[160:163]
    s_waitcnt lgkmcnt(8)
    ds_read_b64_tr_b16 v[100:101], v252 offset:33024
    ds_read_b64_tr_b16 v[102:103], v252 offset:35072
    v_mfma_f32_16x16x32_bf16 v[172:175], v[232:235], v[236:239], v[172:175]
    s_waitcnt lgkmcnt(9)
    ds_read_b128 v[232:235], v250 offset:27392
    ds_read_b64_tr_b16 v[136:137], v251 offset:33280
    v_mfma_f32_16x16x32_bf16 v[176:179], v[212:215], v[236:239], v[176:179]
    ds_read_b64_tr_b16 v[138:139], v251 offset:35328
    ds_read_b64_tr_b16 v[104:105], v252 offset:33280
    v_mfma_f32_16x16x32_bf16 v[164:167], v[212:215], v[116:119], v[164:167]
    s_waitcnt lgkmcnt(12)
    ds_read_b64_tr_b16 v[106:107], v252 offset:35328
    ds_read_b64_tr_b16 v[140:141], v251 offset:33536
    v_mfma_f32_16x16x32_bf16 v[160:163], v[216:219], v[120:123], v[160:163]
    s_waitcnt lgkmcnt(13)
    ds_read_b64_tr_b16 v[142:143], v251 offset:35584
    ds_read_b64_tr_b16 v[108:109], v252 offset:33536
    v_mfma_f32_16x16x32_bf16 v[172:175], v[216:219], v[92:95], v[172:175]
    s_waitcnt lgkmcnt(14)
    ds_read_b64_tr_b16 v[110:111], v252 offset:35584
    ds_read_b64_tr_b16 v[112:113], v251 offset:40960
    v_mfma_f32_16x16x32_bf16 v[176:179], v[220:223], v[92:95], v[176:179]
    ds_read_b64_tr_b16 v[114:115], v251 offset:43008
    ds_read_b64_tr_b16 v[236:237], v251 offset:0
    v_mfma_f32_16x16x32_bf16 v[164:167], v[220:223], v[120:123], v[164:167]
    s_waitcnt lgkmcnt(15)
    ds_read_b64_tr_b16 v[238:239], v251 offset:2048
    ds_read_b64_tr_b16 v[212:213], v252 offset:40960
    v_mfma_f32_16x16x32_bf16 v[160:163], v[224:227], v[124:127], v[160:163]
    ds_read_b64_tr_b16 v[214:215], v252 offset:43008
    ds_read_b64_tr_b16 v[116:117], v252 offset:0
    v_mfma_f32_16x16x32_bf16 v[172:175], v[224:227], v[228:231], v[172:175]
    s_waitcnt lgkmcnt(15)
    ds_read_b64_tr_b16 v[118:119], v252 offset:2048
    ds_read_b64_tr_b16 v[216:217], v251 offset:41216
    v_mfma_f32_16x16x32_bf16 v[176:179], v[232:235], v[228:231], v[176:179]
    ds_read_b64_tr_b16 v[218:219], v251 offset:43264
    ds_read_b64_tr_b16 v[92:93], v251 offset:256
    v_mfma_f32_16x16x32_bf16 v[164:167], v[232:235], v[124:127], v[164:167]
    ds_read_b64_tr_b16 v[94:95], v251 offset:2304
    ds_read_b64_tr_b16 v[220:221], v252 offset:41216
    v_mfma_f32_16x16x32_bf16 a[0:3], v[128:131], v[156:159], a[0:3]
    ds_read_b64_tr_b16 v[222:223], v252 offset:43264
    ds_read_b64_tr_b16 v[120:121], v252 offset:256
    v_mfma_f32_16x16x32_bf16 a[4:7], v[96:99], v[156:159], a[4:7]
    ds_read_b64_tr_b16 v[122:123], v252 offset:2304
    ds_read_b64_tr_b16 v[224:225], v251 offset:41472
    v_mfma_f32_16x16x32_bf16 a[8:11], v[132:135], v[156:159], a[8:11]
    ds_read_b64_tr_b16 v[226:227], v251 offset:43520
    ds_read_b64_tr_b16 v[228:229], v251 offset:512
    v_mfma_f32_16x16x32_bf16 a[12:15], v[100:103], v[156:159], a[12:15]
    s_waitcnt lgkmcnt(15)
    ds_read_b64_tr_b16 v[230:231], v251 offset:2560
    ds_read_b64_tr_b16 v[232:233], v252 offset:41472
    v_mfma_f32_16x16x32_bf16 a[16:19], v[136:139], v[156:159], a[16:19]
    ds_read_b64_tr_b16 v[234:235], v252 offset:43520
    ds_read_b64_tr_b16 v[124:125], v252 offset:512
    v_mfma_f32_16x16x32_bf16 a[20:23], v[104:107], v[156:159], a[20:23]
    ds_read_b64_tr_b16 v[126:127], v252 offset:2560
    ds_read_b64_tr_b16 v[128:129], v251 offset:41728
    v_mfma_f32_16x16x32_bf16 a[24:27], v[140:143], v[156:159], a[24:27]
    ds_read_b64_tr_b16 v[130:131], v251 offset:43776
    v_fma_f32 v160, v160, s26, v241
    v_mfma_f32_16x16x32_bf16 a[28:31], v[108:111], v[156:159], a[28:31]
    ds_read_b64_tr_b16 v[96:97], v251 offset:768
    v_fma_f32 v161, v161, s26, v241
    v_mfma_f32_16x16x32_bf16 a[32:35], v[112:115], v[156:159], a[32:35]
    ds_read_b64_tr_b16 v[98:99], v251 offset:2816
    v_fma_f32 v162, v162, s26, v241
    v_fma_f32 v163, v163, s26, v241
    v_fma_f32 v164, v164, s26, v241
    v_fma_f32 v165, v165, s26, v241
    v_fma_f32 v166, v166, s26, v241
    v_fma_f32 v167, v167, s26, v241
    v_exp_f32 v160, v160
    v_exp_f32 v161, v161
    v_exp_f32 v162, v162
    v_exp_f32 v163, v163
    v_exp_f32 v164, v164
    v_exp_f32 v165, v165
    v_exp_f32 v166, v166
    v_exp_f32 v167, v167
    v_add_f32 v246, v160, v246
    v_add_f32 v246, v161, v246
    v_add_f32 v246, v162, v246
    v_add_f32 v246, v163, v246
    v_cvt_pk_bf16_f32 v160, v160, v161
    v_cvt_pk_bf16_f32 v161, v162, v163
    v_cvt_pk_bf16_f32 v162, v164, v165
    v_cvt_pk_bf16_f32 v163, v166, v167
    v_add_f32 v246, v164, v246
    v_add_f32 v246, v165, v246
    v_mfma_f32_16x16x32_bf16 a[0:3], v[236:239], v[160:163], a[0:3]
    s_waitcnt lgkmcnt(15)
    ds_read_b64_tr_b16 v[132:133], v252 offset:41728
    v_add_f32 v246, v166, v246
    v_mfma_f32_16x16x32_bf16 a[36:39], v[212:215], v[156:159], a[36:39]
    ds_read_b64_tr_b16 v[134:135], v252 offset:43776
    v_add_f32 v246, v167, v246
    v_mov_b32 v164, v246
    v_mfma_f32_16x16x32_bf16 a[4:7], v[116:119], v[160:163], a[4:7]
    ds_read_b64_tr_b16 v[100:101], v252 offset:768
    v_permlane32_swap_b32 v246, v164
    v_add_f32 v246, v246, v164
    v_mov_b32 v164, v246
    v_mfma_f32_16x16x32_bf16 a[40:43], v[216:219], v[156:159], a[40:43]
    ds_read_b64_tr_b16 v[102:103], v252 offset:2816
    v_permlane16_swap_b32 v246, v164
    v_add_f32 v246, v246, v164
    v_add_f32 v240, v240, v246
    v_rcp_f32 v164, v246
    v_mfma_f32_16x16x32_bf16 a[8:11], v[92:95], v[160:163], a[8:11]
    ds_read_b64_tr_b16 v[136:137], v251 offset:8192
    v_mov_b32 v165, v164
    v_accvgpr_read_b32 v0, a0
    v_accvgpr_read_b32 v1, a1
    v_accvgpr_read_b32 v2, a2
    v_accvgpr_read_b32 v3, a3
    v_pk_mul_f32 v[0:1], v[0:1], v[164:165]
    v_pk_mul_f32 v[2:3], v[2:3], v[164:165]
    v_cvt_pk_bf16_f32 v0, v0, v1
    v_cvt_pk_bf16_f32 v1, v2, v3
    s_waitcnt lgkmcnt(15)
    v_mfma_f32_16x16x32_bf16 a[44:47], v[220:223], v[156:159], a[44:47]
    ds_write_b64 v68, v[0:1] offset:0
    ds_read_b64_tr_b16 v[138:139], v251 offset:10240
    ds_read_b64_tr_b16 v[104:105], v252 offset:8192
    ds_read_b64_tr_b16 v[106:107], v252 offset:10240
    ds_read_b64_tr_b16 v[140:141], v251 offset:8448
    ds_read_b64_tr_b16 v[142:143], v251 offset:10496
    v_mfma_f32_16x16x32_bf16 a[12:15], v[120:123], v[160:163], a[12:15]
    ds_read_b64_tr_b16 v[108:109], v252 offset:8448
    ds_read_b64_tr_b16 v[110:111], v252 offset:10496
    v_accvgpr_read_b32 v4, a4
    v_accvgpr_read_b32 v5, a5
    v_accvgpr_read_b32 v6, a6
    v_accvgpr_read_b32 v7, a7
    v_pk_mul_f32 v[4:5], v[4:5], v[164:165]
    v_pk_mul_f32 v[6:7], v[6:7], v[164:165]
    v_cvt_pk_bf16_f32 v4, v4, v5
    v_cvt_pk_bf16_f32 v5, v6, v7
    v_mfma_f32_16x16x32_bf16 a[48:51], v[224:227], v[156:159], a[48:51]
    s_waitcnt lgkmcnt(15)
    ds_write_b64 v69, v[4:5] offset:0
    ds_read_b64_tr_b16 v[112:113], v251 offset:8704
    ds_read_b64_tr_b16 v[114:115], v251 offset:10752
    v_mfma_f32_16x16x32_bf16 a[16:19], v[228:231], v[160:163], a[16:19]
    ds_read_b64_tr_b16 v[236:237], v252 offset:8704
    ds_read_b64_tr_b16 v[238:239], v252 offset:10752
    v_accvgpr_read_b32 v8, a8
    v_accvgpr_read_b32 v9, a9
    v_accvgpr_read_b32 v10, a10
    v_accvgpr_read_b32 v11, a11
    v_pk_mul_f32 v[8:9], v[8:9], v[164:165]
    v_pk_mul_f32 v[10:11], v[10:11], v[164:165]
    v_cvt_pk_bf16_f32 v8, v8, v9
    v_cvt_pk_bf16_f32 v9, v10, v11
    v_mfma_f32_16x16x32_bf16 a[52:55], v[232:235], v[156:159], a[52:55]
    ds_write_b64 v70, v[8:9] offset:0
    ds_read_b64_tr_b16 v[212:213], v251 offset:8960
    ds_read_b64_tr_b16 v[214:215], v251 offset:11008
    v_mfma_f32_16x16x32_bf16 a[20:23], v[124:127], v[160:163], a[20:23]
    ds_read_b64_tr_b16 v[116:117], v252 offset:8960
    ds_read_b64_tr_b16 v[118:119], v252 offset:11008
    v_accvgpr_read_b32 v12, a12
    v_accvgpr_read_b32 v13, a13
    v_accvgpr_read_b32 v14, a14
    v_accvgpr_read_b32 v15, a15
    v_pk_mul_f32 v[12:13], v[12:13], v[164:165]
    v_pk_mul_f32 v[14:15], v[14:15], v[164:165]
    v_cvt_pk_bf16_f32 v12, v12, v13
    v_cvt_pk_bf16_f32 v13, v14, v15
    v_mfma_f32_16x16x32_bf16 a[56:59], v[128:131], v[156:159], a[56:59]
    s_waitcnt lgkmcnt(15)
    ds_write_b64 v71, v[12:13] offset:0
    ds_read_b64_tr_b16 v[216:217], v251 offset:32768
    ds_read_b64_tr_b16 v[218:219], v251 offset:34816
    v_mfma_f32_16x16x32_bf16 a[24:27], v[96:99], v[160:163], a[24:27]
    ds_read_b64_tr_b16 v[92:93], v251 offset:0
    v_accvgpr_read_b32 v16, a16
    v_accvgpr_read_b32 v17, a17
    v_accvgpr_read_b32 v18, a18
    v_accvgpr_read_b32 v19, a19
    v_pk_mul_f32 v[16:17], v[16:17], v[164:165]
    v_pk_mul_f32 v[18:19], v[18:19], v[164:165]
    v_cvt_pk_bf16_f32 v16, v16, v17
    v_cvt_pk_bf16_f32 v17, v18, v19
    v_mfma_f32_16x16x32_bf16 a[60:63], v[132:135], v[156:159], a[60:63]
    ds_write_b64 v68, v[16:17] offset:128
    ds_read_b64_tr_b16 v[94:95], v251 offset:2048
    ds_read_b64_tr_b16 v[220:221], v252 offset:32768
    ds_read_b64_tr_b16 v[222:223], v252 offset:34816
    v_mfma_f32_16x16x32_bf16 a[28:31], v[100:103], v[160:163], a[28:31]
    ds_read_b64_tr_b16 v[120:121], v252 offset:0
    v_accvgpr_read_b32 v20, a20
    v_accvgpr_read_b32 v21, a21
    v_accvgpr_read_b32 v22, a22
    v_accvgpr_read_b32 v23, a23
    v_pk_mul_f32 v[20:21], v[20:21], v[164:165]
    v_pk_mul_f32 v[22:23], v[22:23], v[164:165]
    v_cvt_pk_bf16_f32 v20, v20, v21
    v_cvt_pk_bf16_f32 v21, v22, v23
    v_mfma_f32_16x16x32_bf16 a[32:35], v[136:139], v[160:163], a[32:35]
    ds_write_b64 v69, v[20:21] offset:128
    ds_read_b64_tr_b16 v[122:123], v252 offset:2048
    ds_read_b64_tr_b16 v[224:225], v251 offset:33024
    ds_read_b64_tr_b16 v[226:227], v251 offset:35072
    s_waitcnt lgkmcnt(15)
    v_mfma_f32_16x16x32_bf16 a[36:39], v[104:107], v[160:163], a[36:39]
    ds_read_b64_tr_b16 v[228:229], v251 offset:256
    v_accvgpr_read_b32 v24, a24
    v_accvgpr_read_b32 v25, a25
    v_accvgpr_read_b32 v26, a26
    v_accvgpr_read_b32 v27, a27
    v_pk_mul_f32 v[24:25], v[24:25], v[164:165]
    v_pk_mul_f32 v[26:27], v[26:27], v[164:165]
    v_cvt_pk_bf16_f32 v24, v24, v25
    v_cvt_pk_bf16_f32 v25, v26, v27
    v_mfma_f32_16x16x32_bf16 a[40:43], v[140:143], v[160:163], a[40:43]
    ds_write_b64 v70, v[24:25] offset:128
    ds_read_b64_tr_b16 v[230:231], v251 offset:2304
    ds_read_b64_tr_b16 v[232:233], v252 offset:33024
    ds_read_b64_tr_b16 v[234:235], v252 offset:35072
    v_mfma_f32_16x16x32_bf16 a[44:47], v[108:111], v[160:163], a[44:47]
    ds_read_b64_tr_b16 v[124:125], v252 offset:256
    v_accvgpr_read_b32 v28, a28
    v_accvgpr_read_b32 v29, a29
    v_accvgpr_read_b32 v30, a30
    v_accvgpr_read_b32 v31, a31
    v_pk_mul_f32 v[28:29], v[28:29], v[164:165]
    v_pk_mul_f32 v[30:31], v[30:31], v[164:165]
    v_cvt_pk_bf16_f32 v28, v28, v29
    v_cvt_pk_bf16_f32 v29, v30, v31
    v_mfma_f32_16x16x32_bf16 a[48:51], v[112:115], v[160:163], a[48:51]
    ds_write_b64 v71, v[28:29] offset:128
    ds_read_b128 v[76:79], v64 offset:0
    ds_read_b128 v[80:83], v65 offset:512
    ds_read_b128 v[84:87], v66 offset:1024
    ds_read_b128 v[88:91], v67 offset:1536
    v_accvgpr_read_b32 v32, a32
    v_accvgpr_read_b32 v33, a33
    v_accvgpr_read_b32 v34, a34
    v_accvgpr_read_b32 v35, a35
    v_pk_mul_f32 v[32:33], v[32:33], v[164:165]
    v_pk_mul_f32 v[34:35], v[34:35], v[164:165]
    v_cvt_pk_bf16_f32 v32, v32, v33
    v_cvt_pk_bf16_f32 v33, v34, v35
    v_mfma_f32_16x16x32_bf16 a[52:55], v[236:239], v[160:163], a[52:55]
    ds_write_b64 v68, v[32:33] offset:49152
    ds_read_b64_tr_b16 v[126:127], v252 offset:2304
    ds_read_b64_tr_b16 v[128:129], v251 offset:33280
    ds_read_b64_tr_b16 v[130:131], v251 offset:35328
    v_accvgpr_read_b32 v36, a36
    v_accvgpr_read_b32 v37, a37
    v_accvgpr_read_b32 v38, a38
    v_accvgpr_read_b32 v39, a39
    v_pk_mul_f32 v[36:37], v[36:37], v[164:165]
    v_mfma_f32_16x16x32_bf16 a[56:59], v[212:215], v[160:163], a[56:59]
    ds_read_b64_tr_b16 v[96:97], v251 offset:512
    s_waitcnt lgkmcnt(8)
    buffer_store_dwordx4 v[76:79], v254, s[16:19], s55 offen offset:0 nt
    s_waitcnt lgkmcnt(7)
    buffer_store_dwordx4 v[80:83], v254, s[16:19], s55 offen offset:1024 nt
    s_waitcnt lgkmcnt(6)
    buffer_store_dwordx4 v[84:87], v254, s[16:19], s55 offen offset:2048 nt
    s_waitcnt lgkmcnt(5)
    buffer_store_dwordx4 v[88:91], v254, s[16:19], s55 offen offset:3072 nt
    v_pk_mul_f32 v[38:39], v[38:39], v[164:165]
    v_cvt_pk_bf16_f32 v36, v36, v37
    v_cvt_pk_bf16_f32 v37, v38, v39
    v_accvgpr_read_b32 v40, a40
    v_accvgpr_read_b32 v41, a41
    v_accvgpr_read_b32 v42, a42
    v_accvgpr_read_b32 v43, a43
    v_pk_mul_f32 v[40:41], v[40:41], v[164:165]
    v_pk_mul_f32 v[42:43], v[42:43], v[164:165]
    v_cvt_pk_bf16_f32 v40, v40, v41
    v_cvt_pk_bf16_f32 v41, v42, v43
    v_mfma_f32_16x16x32_bf16 a[60:63], v[116:119], v[160:163], a[60:63]
    ds_write_b64 v69, v[36:37] offset:49152
    ds_write_b64 v70, v[40:41] offset:49152
    ds_read_b64_tr_b16 v[98:99], v251 offset:2560
    ds_read_b64_tr_b16 v[132:133], v252 offset:33280
    ds_read_b64_tr_b16 v[134:135], v252 offset:35328
    v_accvgpr_read_b32 v44, a44
    v_accvgpr_read_b32 v45, a45
    v_accvgpr_read_b32 v46, a46
    v_accvgpr_read_b32 v47, a47
    v_pk_mul_f32 v[44:45], v[44:45], v[164:165]
    v_pk_mul_f32 v[46:47], v[46:47], v[164:165]
    v_cvt_pk_bf16_f32 v44, v44, v45
    v_cvt_pk_bf16_f32 v45, v46, v47
    v_mfma_f32_16x16x32_bf16 a[64:67], v[216:219], v[168:171], a[64:67]
    ds_write_b64 v71, v[44:45] offset:49152
    ds_read_b64_tr_b16 v[100:101], v252 offset:512
    ds_read_b64_tr_b16 v[102:103], v252 offset:2560
    v_accvgpr_read_b32 v48, a48
    v_accvgpr_read_b32 v49, a49
    v_accvgpr_read_b32 v50, a50
    v_accvgpr_read_b32 v51, a51
    v_pk_mul_f32 v[48:49], v[48:49], v[164:165]
    v_pk_mul_f32 v[50:51], v[50:51], v[164:165]
    v_cvt_pk_bf16_f32 v48, v48, v49
    v_cvt_pk_bf16_f32 v49, v50, v51
    v_accvgpr_read_b32 v52, a52
    v_accvgpr_read_b32 v53, a53
    v_accvgpr_read_b32 v54, a54
    v_accvgpr_read_b32 v55, a55
    v_pk_mul_f32 v[52:53], v[52:53], v[164:165]
    v_pk_mul_f32 v[54:55], v[54:55], v[164:165]
    v_cvt_pk_bf16_f32 v52, v52, v53
    v_cvt_pk_bf16_f32 v53, v54, v55
    v_fma_f32 v172, v172, s26, v242
    v_fma_f32 v173, v173, s26, v242
    v_fma_f32 v174, v174, s26, v242
    v_fma_f32 v175, v175, s26, v242
    v_fma_f32 v176, v176, s26, v242
    v_fma_f32 v177, v177, s26, v242
    v_fma_f32 v178, v178, s26, v242
    v_fma_f32 v179, v179, s26, v242
    v_exp_f32 v172, v172
    v_exp_f32 v173, v173
    v_exp_f32 v174, v174
    v_exp_f32 v175, v175
    v_exp_f32 v176, v176
    v_exp_f32 v177, v177
    v_exp_f32 v178, v178
    v_exp_f32 v179, v179
    v_add_f32 v247, v172, v247
    v_add_f32 v247, v173, v247
    v_add_f32 v247, v174, v247
    v_add_f32 v247, v175, v247
    v_cvt_pk_bf16_f32 v172, v172, v173
    v_cvt_pk_bf16_f32 v173, v174, v175
    v_cvt_pk_bf16_f32 v174, v176, v177
    v_cvt_pk_bf16_f32 v175, v178, v179
    v_accvgpr_read_b32 v56, a56
    v_accvgpr_read_b32 v57, a57
    v_mfma_f32_16x16x32_bf16 a[64:67], v[92:95], v[172:175], a[64:67]
    ds_write_b64 v68, v[48:49] offset:49280
    ds_write_b64 v69, v[52:53] offset:49280
    ds_read_b64_tr_b16 v[136:137], v251 offset:33536
    ds_read_b64_tr_b16 v[138:139], v251 offset:35584
    ds_read_b64_tr_b16 v[104:105], v251 offset:768
    ds_read_b64_tr_b16 v[106:107], v251 offset:2816
    v_mfma_f32_16x16x32_bf16 a[68:71], v[220:223], v[168:171], a[68:71]
    ds_read_b64_tr_b16 v[140:141], v252 offset:33536
    v_accvgpr_read_b32 v58, a58
    v_accvgpr_read_b32 v59, a59
    v_add_f32 v247, v176, v247
    v_pk_mul_f32 v[56:57], v[56:57], v[164:165]
    v_pk_mul_f32 v[58:59], v[58:59], v[164:165]
    v_cvt_pk_bf16_f32 v56, v56, v57
    v_cvt_pk_bf16_f32 v57, v58, v59
    v_add_f32 v247, v177, v247
    v_add_f32 v247, v178, v247
    v_add_f32 v247, v179, v247
    v_mov_b32 v176, v247
    v_mfma_f32_16x16x32_bf16 a[68:71], v[120:123], v[172:175], a[68:71]
    ds_write_b64 v70, v[56:57] offset:49280
    v_permlane32_swap_b32 v247, v176
    v_add_f32 v247, v247, v176
    v_mov_b32 v176, v247
    v_accvgpr_read_b32 v60, a60
    v_accvgpr_read_b32 v61, a61
    v_permlane16_swap_b32 v247, v176
    v_add_f32 v247, v247, v176
    v_add_f32 v240, v240, v247
    v_rcp_f32 v176, v247
    v_accvgpr_read_b32 v62, a62
    v_accvgpr_read_b32 v63, a63
    v_pk_mul_f32 v[60:61], v[60:61], v[164:165]
    v_mov_b32 v177, v176
    v_pk_mul_f32 v[62:63], v[62:63], v[164:165]
    v_cvt_pk_bf16_f32 v60, v60, v61
    v_cvt_pk_bf16_f32 v61, v62, v63
    v_mfma_f32_16x16x32_bf16 a[72:75], v[224:227], v[168:171], a[72:75]
    ds_write_b64 v71, v[60:61] offset:49280
    ds_read_b128 v[76:79], v64 offset:49152
    ds_read_b128 v[80:83], v65 offset:49664
    ds_read_b128 v[84:87], v66 offset:50176
    ds_read_b128 v[88:91], v67 offset:50688
    v_mfma_f32_16x16x32_bf16 a[72:75], v[228:231], v[172:175], a[72:75]
    ds_read_b64_tr_b16 v[142:143], v252 offset:35584
    v_accvgpr_read_b32 v0, a64
    v_accvgpr_read_b32 v1, a65
    v_accvgpr_read_b32 v2, a66
    v_accvgpr_read_b32 v3, a67
    v_pk_mul_f32 v[0:1], v[0:1], v[176:177]
    v_pk_mul_f32 v[2:3], v[2:3], v[176:177]
    v_cvt_pk_bf16_f32 v0, v0, v1
    v_cvt_pk_bf16_f32 v1, v2, v3
    v_mfma_f32_16x16x32_bf16 a[76:79], v[232:235], v[168:171], a[76:79]
    ds_read_b64_tr_b16 v[108:109], v252 offset:768
    ds_read_b64_tr_b16 v[110:111], v252 offset:2816
    ds_write_b64 v68, v[0:1] offset:0
    ds_read_b64_tr_b16 v[112:113], v251 offset:40960
    ds_read_b64_tr_b16 v[114:115], v251 offset:43008
    s_waitcnt lgkmcnt(9)
    buffer_store_dwordx4 v[76:79], v254, s[16:19], s55 offen offset:256 nt
    s_waitcnt lgkmcnt(8)
    buffer_store_dwordx4 v[80:83], v254, s[16:19], s55 offen offset:1280 nt
    s_waitcnt lgkmcnt(7)
    buffer_store_dwordx4 v[84:87], v254, s[16:19], s55 offen offset:2304 nt
    s_waitcnt lgkmcnt(6)
    buffer_store_dwordx4 v[88:91], v254, s[16:19], s55 offen offset:3328 nt
    ds_read_b64_tr_b16 v[236:237], v251 offset:8192
    ds_read_b64_tr_b16 v[238:239], v251 offset:10240
    ds_read_b64_tr_b16 v[212:213], v252 offset:40960
    ds_read_b64_tr_b16 v[214:215], v252 offset:43008
    v_mfma_f32_16x16x32_bf16 a[76:79], v[124:127], v[172:175], a[76:79]
    ds_read_b64_tr_b16 v[116:117], v252 offset:8192
    ds_read_b64_tr_b16 v[118:119], v252 offset:10240
    v_accvgpr_read_b32 v4, a68
    v_accvgpr_read_b32 v5, a69
    v_accvgpr_read_b32 v6, a70
    v_accvgpr_read_b32 v7, a71
    v_pk_mul_f32 v[4:5], v[4:5], v[176:177]
    v_pk_mul_f32 v[6:7], v[6:7], v[176:177]
    v_cvt_pk_bf16_f32 v4, v4, v5
    v_cvt_pk_bf16_f32 v5, v6, v7
    v_mfma_f32_16x16x32_bf16 a[80:83], v[128:131], v[168:171], a[80:83]
    ds_write_b64 v69, v[4:5] offset:0
    ds_read_b64_tr_b16 v[216:217], v251 offset:41216
    ds_read_b64_tr_b16 v[218:219], v251 offset:43264
    v_mfma_f32_16x16x32_bf16 a[80:83], v[96:99], v[172:175], a[80:83]
    ds_read_b64_tr_b16 v[92:93], v251 offset:8448
    ds_read_b64_tr_b16 v[94:95], v251 offset:10496
    v_accvgpr_read_b32 v8, a72
    v_accvgpr_read_b32 v9, a73
    v_accvgpr_read_b32 v10, a74
    v_accvgpr_read_b32 v11, a75
    v_pk_mul_f32 v[8:9], v[8:9], v[176:177]
    v_pk_mul_f32 v[10:11], v[10:11], v[176:177]
    v_cvt_pk_bf16_f32 v8, v8, v9
    v_cvt_pk_bf16_f32 v9, v10, v11
    v_mfma_f32_16x16x32_bf16 a[84:87], v[132:135], v[168:171], a[84:87]
    ds_write_b64 v70, v[8:9] offset:0
    ds_read_b64_tr_b16 v[220:221], v252 offset:41216
    ds_read_b64_tr_b16 v[222:223], v252 offset:43264
    v_mfma_f32_16x16x32_bf16 a[84:87], v[100:103], v[172:175], a[84:87]
    ds_read_b64_tr_b16 v[120:121], v252 offset:8448
    ds_read_b64_tr_b16 v[122:123], v252 offset:10496
    v_accvgpr_read_b32 v12, a76
    v_accvgpr_read_b32 v13, a77
    v_accvgpr_read_b32 v14, a78
    v_accvgpr_read_b32 v15, a79
    v_pk_mul_f32 v[12:13], v[12:13], v[176:177]
    v_pk_mul_f32 v[14:15], v[14:15], v[176:177]
    v_cvt_pk_bf16_f32 v12, v12, v13
    v_cvt_pk_bf16_f32 v13, v14, v15
    v_mfma_f32_16x16x32_bf16 a[88:91], v[136:139], v[168:171], a[88:91]
    ds_write_b64 v71, v[12:13] offset:0
    ds_read_b64_tr_b16 v[224:225], v251 offset:41472
    ds_read_b64_tr_b16 v[226:227], v251 offset:43520
    v_mfma_f32_16x16x32_bf16 a[88:91], v[104:107], v[172:175], a[88:91]
    ds_read_b64_tr_b16 v[228:229], v251 offset:8704
    ds_read_b64_tr_b16 v[230:231], v251 offset:10752
    v_accvgpr_read_b32 v16, a80
    v_accvgpr_read_b32 v17, a81
    v_accvgpr_read_b32 v18, a82
    v_accvgpr_read_b32 v19, a83
    v_pk_mul_f32 v[16:17], v[16:17], v[176:177]
    v_pk_mul_f32 v[18:19], v[18:19], v[176:177]
    v_cvt_pk_bf16_f32 v16, v16, v17
    v_cvt_pk_bf16_f32 v17, v18, v19
    s_waitcnt lgkmcnt(15)
    v_mfma_f32_16x16x32_bf16 a[92:95], v[140:143], v[168:171], a[92:95]
    ds_write_b64 v68, v[16:17] offset:128
    ds_read_b64_tr_b16 v[232:233], v252 offset:41472
    ds_read_b64_tr_b16 v[234:235], v252 offset:43520
    v_mfma_f32_16x16x32_bf16 a[92:95], v[108:111], v[172:175], a[92:95]
    ds_read_b64_tr_b16 v[124:125], v252 offset:8704
    ds_read_b64_tr_b16 v[126:127], v252 offset:10752
    v_accvgpr_read_b32 v20, a84
    v_accvgpr_read_b32 v21, a85
    v_accvgpr_read_b32 v22, a86
    v_accvgpr_read_b32 v23, a87
    v_pk_mul_f32 v[20:21], v[20:21], v[176:177]
    v_pk_mul_f32 v[22:23], v[22:23], v[176:177]
    v_cvt_pk_bf16_f32 v20, v20, v21
    v_cvt_pk_bf16_f32 v21, v22, v23
    v_mfma_f32_16x16x32_bf16 a[96:99], v[112:115], v[168:171], a[96:99]
    ds_write_b64 v69, v[20:21] offset:128
    ds_read_b64_tr_b16 v[128:129], v251 offset:41728
    ds_read_b64_tr_b16 v[130:131], v251 offset:43776
    v_mfma_f32_16x16x32_bf16 a[96:99], v[236:239], v[172:175], a[96:99]
    ds_read_b64_tr_b16 v[96:97], v251 offset:8960
    ds_read_b64_tr_b16 v[98:99], v251 offset:11008
    v_accvgpr_read_b32 v24, a88
    v_accvgpr_read_b32 v25, a89
    v_accvgpr_read_b32 v26, a90
    v_accvgpr_read_b32 v27, a91
    v_pk_mul_f32 v[24:25], v[24:25], v[176:177]
    v_pk_mul_f32 v[26:27], v[26:27], v[176:177]
    v_cvt_pk_bf16_f32 v24, v24, v25
    v_cvt_pk_bf16_f32 v25, v26, v27
    v_mfma_f32_16x16x32_bf16 a[100:103], v[212:215], v[168:171], a[100:103]
    ds_write_b64 v70, v[24:25] offset:128
    ds_read_b64_tr_b16 v[132:133], v252 offset:41728
    ds_read_b64_tr_b16 v[134:135], v252 offset:43776
    v_mfma_f32_16x16x32_bf16 a[100:103], v[116:119], v[172:175], a[100:103]
    ds_read_b64_tr_b16 v[100:101], v252 offset:8960
    ds_read_b64_tr_b16 v[102:103], v252 offset:11008
    v_accvgpr_read_b32 v28, a92
    v_accvgpr_read_b32 v29, a93
    v_accvgpr_read_b32 v30, a94
    v_accvgpr_read_b32 v31, a95
    v_pk_mul_f32 v[28:29], v[28:29], v[176:177]
    v_pk_mul_f32 v[30:31], v[30:31], v[176:177]
    v_cvt_pk_bf16_f32 v28, v28, v29
    v_cvt_pk_bf16_f32 v29, v30, v31
    s_waitcnt lgkmcnt(15)
    v_mfma_f32_16x16x32_bf16 a[104:107], v[216:219], v[168:171], a[104:107]
    ds_write_b64 v71, v[28:29] offset:128
    ds_read_b128 v[76:79], v64 offset:0
    ds_read_b128 v[80:83], v65 offset:512
    ds_read_b128 v[84:87], v66 offset:1024
    ds_read_b128 v[88:91], v67 offset:1536
    v_mfma_f32_16x16x32_bf16 a[104:107], v[92:95], v[172:175], a[104:107]
    ds_read_b128 v[136:139], v250 offset:16384
    v_accvgpr_read_b32 v32, a96
    v_accvgpr_read_b32 v33, a97
    v_accvgpr_read_b32 v34, a98
    v_accvgpr_read_b32 v35, a99
    v_pk_mul_f32 v[32:33], v[32:33], v[176:177]
    v_pk_mul_f32 v[34:35], v[34:35], v[176:177]
    v_cvt_pk_bf16_f32 v32, v32, v33
    v_cvt_pk_bf16_f32 v33, v34, v35
    v_mfma_f32_16x16x32_bf16 a[108:111], v[220:223], v[168:171], a[108:111]
    ds_write_b64 v68, v[32:33] offset:49152
    ds_read_b128 v[104:107], v253 offset:4096
    v_mfma_f32_16x16x32_bf16 a[108:111], v[120:123], v[172:175], a[108:111]
    ds_read_b128 v[140:143], v253 offset:12288
    v_accvgpr_read_b32 v36, a100
    v_accvgpr_read_b32 v37, a101
    v_accvgpr_read_b32 v38, a102
    v_mfma_f32_16x16x32_bf16 a[112:115], v[224:227], v[168:171], a[112:115]
    ds_read_b128 v[108:111], v250 offset:18432
    s_waitcnt lgkmcnt(8)
    buffer_store_dwordx4 v[76:79], v254, s[16:19], s56 offen offset:0 nt
    s_waitcnt lgkmcnt(7)
    buffer_store_dwordx4 v[80:83], v254, s[16:19], s56 offen offset:1024 nt
    s_waitcnt lgkmcnt(6)
    buffer_store_dwordx4 v[84:87], v254, s[16:19], s56 offen offset:2048 nt
    s_waitcnt lgkmcnt(5)
    buffer_store_dwordx4 v[88:91], v254, s[16:19], s56 offen offset:3072 nt
    v_accvgpr_read_b32 v39, a103
    v_pk_mul_f32 v[36:37], v[36:37], v[176:177]
    v_pk_mul_f32 v[38:39], v[38:39], v[176:177]
    v_cvt_pk_bf16_f32 v36, v36, v37
    v_cvt_pk_bf16_f32 v37, v38, v39
    v_mfma_f32_16x16x32_bf16 a[112:115], v[228:231], v[172:175], a[112:115]
    ds_write_b64 v69, v[36:37] offset:49152
    ds_read_b128 v[112:115], v250 offset:16640
    ds_read_b128 v[236:239], v253 offset:4352
    v_accvgpr_read_b32 v40, a104
    v_accvgpr_read_b32 v41, a105
    v_accvgpr_read_b32 v42, a106
    v_accvgpr_read_b32 v43, a107
    v_pk_mul_f32 v[40:41], v[40:41], v[176:177]
    v_pk_mul_f32 v[42:43], v[42:43], v[176:177]
    v_cvt_pk_bf16_f32 v40, v40, v41
    v_cvt_pk_bf16_f32 v41, v42, v43
    v_mfma_f32_16x16x32_bf16 a[116:119], v[232:235], v[168:171], a[116:119]
    ds_write_b64 v70, v[40:41] offset:49152
    ds_read_b128 v[212:215], v253 offset:12544
    ds_read_b128 v[116:119], v250 offset:18688
    v_mfma_f32_16x16x32_bf16 a[116:119], v[124:127], v[172:175], a[116:119]
    ds_read_b128 v[216:219], v250 offset:16896
    v_accvgpr_read_b32 v44, a108
    v_accvgpr_read_b32 v45, a109
    v_accvgpr_read_b32 v46, a110
    v_accvgpr_read_b32 v47, a111
    v_pk_mul_f32 v[44:45], v[44:45], v[176:177]
    v_pk_mul_f32 v[46:47], v[46:47], v[176:177]
    v_cvt_pk_bf16_f32 v44, v44, v45
    v_cvt_pk_bf16_f32 v45, v46, v47
    v_mfma_f32_16x16x32_bf16 a[120:123], v[128:131], v[168:171], a[120:123]
    ds_write_b64 v71, v[44:45] offset:49152
    ds_read_b128 v[92:95], v253 offset:4608
    v_mfma_f32_16x16x32_bf16 a[120:123], v[96:99], v[172:175], a[120:123]
    ds_read_b128 v[220:223], v253 offset:12800
    v_accvgpr_read_b32 v48, a112
    v_accvgpr_read_b32 v49, a113
    v_accvgpr_read_b32 v50, a114
    v_accvgpr_read_b32 v51, a115
    v_pk_mul_f32 v[48:49], v[48:49], v[176:177]
    v_pk_mul_f32 v[50:51], v[50:51], v[176:177]
    v_cvt_pk_bf16_f32 v48, v48, v49
    v_cvt_pk_bf16_f32 v49, v50, v51
    v_mfma_f32_16x16x32_bf16 a[124:127], v[132:135], v[168:171], a[124:127]
    ds_write_b64 v68, v[48:49] offset:49280
    ds_read_b128 v[120:123], v250 offset:18944
    v_mfma_f32_16x16x32_bf16 a[124:127], v[100:103], v[172:175], a[124:127]
    ds_read_b128 v[224:227], v250 offset:17152
    v_accvgpr_read_b32 v52, a116
    v_accvgpr_read_b32 v53, a117
    v_accvgpr_read_b32 v54, a118
    v_accvgpr_read_b32 v55, a119
    v_pk_mul_f32 v[52:53], v[52:53], v[176:177]
    v_pk_mul_f32 v[54:55], v[54:55], v[176:177]
    v_cvt_pk_bf16_f32 v52, v52, v53
    v_cvt_pk_bf16_f32 v53, v54, v55
    s_waitcnt lgkmcnt(15)
    v_mfma_f32_16x16x32_bf16 v[184:187], v[136:139], v[104:107], 0
    s_waitcnt lgkmcnt(14)
    ds_write_b64 v69, v[52:53] offset:49280
    ds_read_b128 v[228:231], v253 offset:4864
    v_mfma_f32_16x16x32_bf16 v[200:203], v[136:139], v[140:143], 0
    ds_read_b128 v[232:235], v253 offset:13056
    v_accvgpr_read_b32 v56, a120
    v_accvgpr_read_b32 v57, a121
    v_accvgpr_read_b32 v58, a122
    v_accvgpr_read_b32 v59, a123
    v_pk_mul_f32 v[56:57], v[56:57], v[176:177]
    v_pk_mul_f32 v[58:59], v[58:59], v[176:177]
    v_cvt_pk_bf16_f32 v56, v56, v57
    v_cvt_pk_bf16_f32 v57, v58, v59
    s_waitcnt lgkmcnt(15)
    v_mfma_f32_16x16x32_bf16 v[208:211], v[108:111], v[140:143], 0
    ds_write_b64 v70, v[56:57] offset:49280
    ds_read_b128 v[124:127], v250 offset:19200
    v_mfma_f32_16x16x32_bf16 v[192:195], v[108:111], v[104:107], 0
    ds_read_b128 v[128:131], v250 offset:24576
    v_accvgpr_read_b32 v60, a124
    v_accvgpr_read_b32 v61, a125
    v_accvgpr_read_b32 v62, a126
    v_accvgpr_read_b32 v63, a127
    v_pk_mul_f32 v[60:61], v[60:61], v[176:177]
    v_pk_mul_f32 v[62:63], v[62:63], v[176:177]
    v_cvt_pk_bf16_f32 v60, v60, v61
    v_cvt_pk_bf16_f32 v61, v62, v63
    s_waitcnt lgkmcnt(15)
    v_mfma_f32_16x16x32_bf16 v[184:187], v[112:115], v[236:239], v[184:187]
    ds_write_b64 v71, v[60:61] offset:49280
    ds_read_b128 v[76:79], v64 offset:49152
    ds_read_b128 v[80:83], v65 offset:49664
    ds_read_b128 v[84:87], v66 offset:50176
    ds_read_b128 v[88:91], v67 offset:50688
    s_waitcnt lgkmcnt(15)
    v_mfma_f32_16x16x32_bf16 v[200:203], v[112:115], v[212:215], v[200:203]
    ds_read_b128 v[96:99], v253 offset:8192
    v_mfma_f32_16x16x32_bf16 v[208:211], v[116:119], v[212:215], v[208:211]
    ds_read_b128 v[132:135], v253 offset:16384
    v_mfma_f32_16x16x32_bf16 v[192:195], v[116:119], v[236:239], v[192:195]
    ds_read_b128 v[100:103], v250 offset:26624
    v_mfma_f32_16x16x32_bf16 v[184:187], v[216:219], v[92:95], v[184:187]
    s_waitcnt lgkmcnt(15)
    ds_read_b128 v[136:139], v250 offset:24832
    v_mfma_f32_16x16x32_bf16 v[200:203], v[216:219], v[220:223], v[200:203]
    ds_read_b128 v[140:143], v253 offset:8448
    v_mfma_f32_16x16x32_bf16 v[208:211], v[120:123], v[220:223], v[208:211]
    ds_read_b128 v[104:107], v253 offset:16640
    s_waitcnt lgkmcnt(9)
    buffer_store_dwordx4 v[76:79], v254, s[16:19], s56 offen offset:256 nt
    s_waitcnt lgkmcnt(8)
    buffer_store_dwordx4 v[80:83], v254, s[16:19], s56 offen offset:1280 nt
    s_waitcnt lgkmcnt(7)
    buffer_store_dwordx4 v[84:87], v254, s[16:19], s56 offen offset:2304 nt
    s_waitcnt lgkmcnt(6)
    buffer_store_dwordx4 v[88:91], v254, s[16:19], s56 offen offset:3328 nt
    ds_read_b128 v[108:111], v250 offset:26880
    v_mfma_f32_16x16x32_bf16 v[192:195], v[120:123], v[92:95], v[192:195]
    ds_read_b128 v[112:115], v250 offset:25088
    ds_read_b128 v[212:215], v253 offset:8704
    v_mfma_f32_16x16x32_bf16 v[184:187], v[224:227], v[228:231], v[184:187]
    ds_read_b128 v[236:239], v253 offset:16896
    ds_read_b128 v[116:119], v250 offset:27136
    v_mfma_f32_16x16x32_bf16 v[200:203], v[224:227], v[232:235], v[200:203]
    ds_read_b128 v[216:219], v250 offset:25344
    ds_read_b128 v[220:223], v253 offset:8960
    v_mfma_f32_16x16x32_bf16 v[208:211], v[124:127], v[232:235], v[208:211]
    ds_read_b128 v[92:95], v253 offset:17152
    v_mfma_f32_16x16x32_bf16 v[192:195], v[124:127], v[228:231], v[192:195]
    s_waitcnt lgkmcnt(13)
    ds_read_b128 v[120:123], v250 offset:27392
    v_mfma_f32_16x16x32_bf16 v[184:187], v[128:131], v[96:99], v[184:187]
    s_waitcnt lgkmcnt(13)
    ds_read_b64_tr_b16 v[224:225], v251 offset:32768
    ds_read_b64_tr_b16 v[226:227], v251 offset:34816
    v_mfma_f32_16x16x32_bf16 v[200:203], v[128:131], v[132:135], v[200:203]
    s_waitcnt lgkmcnt(14)
    ds_read_b64_tr_b16 v[232:233], v252 offset:32768
    ds_read_b64_tr_b16 v[234:235], v252 offset:34816
    v_mfma_f32_16x16x32_bf16 v[208:211], v[100:103], v[132:135], v[208:211]
    ds_read_b64_tr_b16 v[228:229], v251 offset:33024
    ds_read_b64_tr_b16 v[230:231], v251 offset:35072
    v_mfma_f32_16x16x32_bf16 v[192:195], v[100:103], v[96:99], v[192:195]
    s_waitcnt lgkmcnt(15)
    ds_read_b64_tr_b16 v[124:125], v252 offset:33024
    ds_read_b64_tr_b16 v[126:127], v252 offset:35072
    v_mfma_f32_16x16x32_bf16 v[184:187], v[136:139], v[140:143], v[184:187]
    ds_read_b64_tr_b16 v[128:129], v251 offset:33280
    ds_read_b64_tr_b16 v[130:131], v251 offset:35328
    v_mfma_f32_16x16x32_bf16 v[200:203], v[136:139], v[104:107], v[200:203]
    s_waitcnt lgkmcnt(15)
    ds_read_b64_tr_b16 v[132:133], v252 offset:33280
    ds_read_b64_tr_b16 v[134:135], v252 offset:35328
    v_mfma_f32_16x16x32_bf16 v[208:211], v[108:111], v[104:107], v[208:211]
    ds_read_b64_tr_b16 v[96:97], v251 offset:33536
    ds_read_b64_tr_b16 v[98:99], v251 offset:35584
    v_mfma_f32_16x16x32_bf16 v[192:195], v[108:111], v[140:143], v[192:195]
    ds_read_b64_tr_b16 v[100:101], v252 offset:33536
    ds_read_b64_tr_b16 v[102:103], v252 offset:35584
    v_mfma_f32_16x16x32_bf16 v[184:187], v[112:115], v[212:215], v[184:187]
    ds_read_b64_tr_b16 v[136:137], v251 offset:40960
    ds_read_b64_tr_b16 v[138:139], v251 offset:43008
    v_mfma_f32_16x16x32_bf16 v[200:203], v[112:115], v[236:239], v[200:203]
    s_waitcnt lgkmcnt(15)
    ds_read_b64_tr_b16 v[104:105], v251 offset:0
    ds_read_b64_tr_b16 v[106:107], v251 offset:2048
    v_mfma_f32_16x16x32_bf16 v[208:211], v[116:119], v[236:239], v[208:211]
    ds_read_b64_tr_b16 v[108:109], v252 offset:40960
    ds_read_b64_tr_b16 v[110:111], v252 offset:43008
    v_mfma_f32_16x16x32_bf16 v[192:195], v[116:119], v[212:215], v[192:195]
    ds_read_b64_tr_b16 v[140:141], v252 offset:0
    ds_read_b64_tr_b16 v[142:143], v252 offset:2048
    v_mfma_f32_16x16x32_bf16 v[184:187], v[216:219], v[220:223], v[184:187]
    ds_read_b64_tr_b16 v[112:113], v251 offset:41216
    ds_read_b64_tr_b16 v[114:115], v251 offset:43264
    v_mfma_f32_16x16x32_bf16 v[200:203], v[216:219], v[92:95], v[200:203]
    ds_read_b64_tr_b16 v[236:237], v251 offset:256
    ds_read_b64_tr_b16 v[238:239], v251 offset:2304
    v_mfma_f32_16x16x32_bf16 v[208:211], v[120:123], v[92:95], v[208:211]
    ds_read_b64_tr_b16 v[212:213], v252 offset:41216
    ds_read_b64_tr_b16 v[214:215], v252 offset:43264
    v_mfma_f32_16x16x32_bf16 v[192:195], v[120:123], v[220:223], v[192:195]
    ds_read_b64_tr_b16 v[116:117], v252 offset:256
    ds_read_b64_tr_b16 v[118:119], v252 offset:2304
    v_mfma_f32_16x16x32_bf16 a[128:131], v[224:227], v[180:183], a[128:131]
    s_waitcnt lgkmcnt(15)
    ds_read_b64_tr_b16 v[216:217], v251 offset:41472
    ds_read_b64_tr_b16 v[218:219], v251 offset:43520
    v_mfma_f32_16x16x32_bf16 a[132:135], v[232:235], v[180:183], a[132:135]
    ds_read_b64_tr_b16 v[92:93], v251 offset:512
    ds_read_b64_tr_b16 v[94:95], v251 offset:2560
    v_mfma_f32_16x16x32_bf16 a[136:139], v[228:231], v[180:183], a[136:139]
    ds_read_b64_tr_b16 v[220:221], v252 offset:41472
    ds_read_b64_tr_b16 v[222:223], v252 offset:43520
    v_mfma_f32_16x16x32_bf16 a[140:143], v[124:127], v[180:183], a[140:143]
    ds_read_b64_tr_b16 v[120:121], v252 offset:512
    ds_read_b64_tr_b16 v[122:123], v252 offset:2560
    v_mfma_f32_16x16x32_bf16 a[144:147], v[128:131], v[180:183], a[144:147]
    ds_read_b64_tr_b16 v[224:225], v251 offset:41728
    ds_read_b64_tr_b16 v[226:227], v251 offset:43776
    v_mfma_f32_16x16x32_bf16 a[148:151], v[132:135], v[180:183], a[148:151]
    ds_read_b64_tr_b16 v[232:233], v251 offset:768
    v_fma_f32 v184, v184, s26, v243
    v_mfma_f32_16x16x32_bf16 a[152:155], v[96:99], v[180:183], a[152:155]
    ds_read_b64_tr_b16 v[234:235], v251 offset:2816
    v_fma_f32 v185, v185, s26, v243
    v_mfma_f32_16x16x32_bf16 a[156:159], v[100:103], v[180:183], a[156:159]
    s_waitcnt lgkmcnt(15)
    ds_read_b64_tr_b16 v[228:229], v252 offset:41728
    v_fma_f32 v186, v186, s26, v243
    v_mfma_f32_16x16x32_bf16 a[160:163], v[136:139], v[180:183], a[160:163]
    ds_read_b64_tr_b16 v[230:231], v252 offset:43776
    v_fma_f32 v187, v187, s26, v243
    v_fma_f32 v192, v192, s26, v243
    v_fma_f32 v193, v193, s26, v243
    v_fma_f32 v194, v194, s26, v243
    v_fma_f32 v195, v195, s26, v243
    v_exp_f32 v184, v184
    v_exp_f32 v185, v185
    v_exp_f32 v186, v186
    v_exp_f32 v187, v187
    v_exp_f32 v192, v192
    v_exp_f32 v193, v193
    v_exp_f32 v194, v194
    v_exp_f32 v195, v195
    v_add_f32 v248, v184, v248
    v_add_f32 v248, v185, v248
    v_add_f32 v248, v186, v248
    v_add_f32 v248, v187, v248
    v_cvt_pk_bf16_f32 v184, v184, v185
    v_cvt_pk_bf16_f32 v185, v186, v187
    v_cvt_pk_bf16_f32 v186, v192, v193
    v_cvt_pk_bf16_f32 v187, v194, v195
    v_add_f32 v248, v192, v248
    v_add_f32 v248, v193, v248
    v_mfma_f32_16x16x32_bf16 a[128:131], v[104:107], v[184:187], a[128:131]
    ds_read_b64_tr_b16 v[124:125], v252 offset:768
    v_add_f32 v248, v194, v248
    v_mfma_f32_16x16x32_bf16 a[164:167], v[108:111], v[180:183], a[164:167]
    ds_read_b64_tr_b16 v[126:127], v252 offset:2816
    v_add_f32 v248, v195, v248
    v_mov_b32 v192, v248
    v_mfma_f32_16x16x32_bf16 a[132:135], v[140:143], v[184:187], a[132:135]
    ds_read_b64_tr_b16 v[128:129], v251 offset:8192
    v_permlane32_swap_b32 v248, v192
    v_add_f32 v248, v248, v192
    v_mov_b32 v192, v248
    v_mfma_f32_16x16x32_bf16 a[168:171], v[112:115], v[180:183], a[168:171]
    ds_read_b64_tr_b16 v[130:131], v251 offset:10240
    v_permlane16_swap_b32 v248, v192
    v_add_f32 v248, v248, v192
    v_add_f32 v240, v240, v248
    v_rcp_f32 v192, v248
    v_mfma_f32_16x16x32_bf16 a[136:139], v[236:239], v[184:187], a[136:139]
    ds_read_b64_tr_b16 v[132:133], v252 offset:8192
    v_mov_b32 v193, v192
    v_accvgpr_read_b32 v0, a128
    v_accvgpr_read_b32 v1, a129
    v_accvgpr_read_b32 v2, a130
    v_accvgpr_read_b32 v3, a131
    v_pk_mul_f32 v[0:1], v[0:1], v[192:193]
    v_pk_mul_f32 v[2:3], v[2:3], v[192:193]
    v_cvt_pk_bf16_f32 v0, v0, v1
    v_cvt_pk_bf16_f32 v1, v2, v3
    s_waitcnt lgkmcnt(15)
    v_mfma_f32_16x16x32_bf16 a[172:175], v[212:215], v[180:183], a[172:175]
    ds_write_b64 v68, v[0:1] offset:0
    ds_read_b64_tr_b16 v[134:135], v252 offset:10240
    ds_read_b64_tr_b16 v[96:97], v251 offset:8448
    ds_read_b64_tr_b16 v[98:99], v251 offset:10496
    v_mfma_f32_16x16x32_bf16 a[140:143], v[116:119], v[184:187], a[140:143]
    ds_read_b64_tr_b16 v[100:101], v252 offset:8448
    ds_read_b64_tr_b16 v[102:103], v252 offset:10496
    v_accvgpr_read_b32 v4, a132
    v_accvgpr_read_b32 v5, a133
    v_accvgpr_read_b32 v6, a134
    v_accvgpr_read_b32 v7, a135
    v_pk_mul_f32 v[4:5], v[4:5], v[192:193]
    v_pk_mul_f32 v[6:7], v[6:7], v[192:193]
    v_cvt_pk_bf16_f32 v4, v4, v5
    v_cvt_pk_bf16_f32 v5, v6, v7
    v_mfma_f32_16x16x32_bf16 a[176:179], v[216:219], v[180:183], a[176:179]
    ds_write_b64 v69, v[4:5] offset:0
    ds_read_b64_tr_b16 v[136:137], v251 offset:8704
    ds_read_b64_tr_b16 v[138:139], v251 offset:10752
    v_mfma_f32_16x16x32_bf16 a[144:147], v[92:95], v[184:187], a[144:147]
    ds_read_b64_tr_b16 v[104:105], v252 offset:8704
    ds_read_b64_tr_b16 v[106:107], v252 offset:10752
    v_accvgpr_read_b32 v8, a136
    v_accvgpr_read_b32 v9, a137
    v_accvgpr_read_b32 v10, a138
    v_accvgpr_read_b32 v11, a139
    v_pk_mul_f32 v[8:9], v[8:9], v[192:193]
    v_pk_mul_f32 v[10:11], v[10:11], v[192:193]
    v_cvt_pk_bf16_f32 v8, v8, v9
    v_cvt_pk_bf16_f32 v9, v10, v11
    s_waitcnt lgkmcnt(15)
    v_mfma_f32_16x16x32_bf16 a[180:183], v[220:223], v[180:183], a[180:183]
    ds_write_b64 v70, v[8:9] offset:0
    ds_read_b64_tr_b16 v[108:109], v251 offset:8960
    ds_read_b64_tr_b16 v[110:111], v251 offset:11008
    v_mfma_f32_16x16x32_bf16 a[148:151], v[120:123], v[184:187], a[148:151]
    ds_read_b64_tr_b16 v[140:141], v252 offset:8960
    ds_read_b64_tr_b16 v[142:143], v252 offset:11008
    v_accvgpr_read_b32 v12, a140
    v_accvgpr_read_b32 v13, a141
    v_accvgpr_read_b32 v14, a142
    v_accvgpr_read_b32 v15, a143
    v_pk_mul_f32 v[12:13], v[12:13], v[192:193]
    v_pk_mul_f32 v[14:15], v[14:15], v[192:193]
    v_cvt_pk_bf16_f32 v12, v12, v13
    v_cvt_pk_bf16_f32 v13, v14, v15
    v_mfma_f32_16x16x32_bf16 a[184:187], v[224:227], v[180:183], a[184:187]
    ds_write_b64 v71, v[12:13] offset:0
    ds_read_b64_tr_b16 v[112:113], v251 offset:32768
    ds_read_b64_tr_b16 v[114:115], v251 offset:34816
    v_mfma_f32_16x16x32_bf16 a[152:155], v[232:235], v[184:187], a[152:155]
    ds_read_b64_tr_b16 v[236:237], v251 offset:0
    v_accvgpr_read_b32 v16, a144
    v_accvgpr_read_b32 v17, a145
    v_accvgpr_read_b32 v18, a146
    v_accvgpr_read_b32 v19, a147
    v_pk_mul_f32 v[16:17], v[16:17], v[192:193]
    v_pk_mul_f32 v[18:19], v[18:19], v[192:193]
    v_cvt_pk_bf16_f32 v16, v16, v17
    v_cvt_pk_bf16_f32 v17, v18, v19
    v_mfma_f32_16x16x32_bf16 a[188:191], v[228:231], v[180:183], a[188:191]
    ds_write_b64 v68, v[16:17] offset:128
    ds_read_b64_tr_b16 v[238:239], v251 offset:2048
    ds_read_b64_tr_b16 v[212:213], v252 offset:32768
    ds_read_b64_tr_b16 v[214:215], v252 offset:34816
    s_waitcnt lgkmcnt(15)
    v_mfma_f32_16x16x32_bf16 a[156:159], v[124:127], v[184:187], a[156:159]
    ds_read_b64_tr_b16 v[116:117], v252 offset:0
    v_accvgpr_read_b32 v20, a148
    v_accvgpr_read_b32 v21, a149
    v_accvgpr_read_b32 v22, a150
    v_accvgpr_read_b32 v23, a151
    v_pk_mul_f32 v[20:21], v[20:21], v[192:193]
    v_pk_mul_f32 v[22:23], v[22:23], v[192:193]
    v_cvt_pk_bf16_f32 v20, v20, v21
    v_cvt_pk_bf16_f32 v21, v22, v23
    v_mfma_f32_16x16x32_bf16 a[160:163], v[128:131], v[184:187], a[160:163]
    ds_write_b64 v69, v[20:21] offset:128
    ds_read_b64_tr_b16 v[118:119], v252 offset:2048
    ds_read_b64_tr_b16 v[216:217], v251 offset:33024
    ds_read_b64_tr_b16 v[218:219], v251 offset:35072
    v_mfma_f32_16x16x32_bf16 a[164:167], v[132:135], v[184:187], a[164:167]
    ds_read_b64_tr_b16 v[92:93], v251 offset:256
    v_accvgpr_read_b32 v24, a152
    v_accvgpr_read_b32 v25, a153
    v_accvgpr_read_b32 v26, a154
    v_accvgpr_read_b32 v27, a155
    v_pk_mul_f32 v[24:25], v[24:25], v[192:193]
    v_pk_mul_f32 v[26:27], v[26:27], v[192:193]
    v_cvt_pk_bf16_f32 v24, v24, v25
    v_cvt_pk_bf16_f32 v25, v26, v27
    v_mfma_f32_16x16x32_bf16 a[168:171], v[96:99], v[184:187], a[168:171]
    ds_write_b64 v70, v[24:25] offset:128
    ds_read_b64_tr_b16 v[94:95], v251 offset:2304
    ds_read_b64_tr_b16 v[220:221], v252 offset:33024
    ds_read_b64_tr_b16 v[222:223], v252 offset:35072
    v_mfma_f32_16x16x32_bf16 a[172:175], v[100:103], v[184:187], a[172:175]
    ds_read_b64_tr_b16 v[120:121], v252 offset:256
    v_accvgpr_read_b32 v28, a156
    v_accvgpr_read_b32 v29, a157
    v_accvgpr_read_b32 v30, a158
    v_accvgpr_read_b32 v31, a159
    v_pk_mul_f32 v[28:29], v[28:29], v[192:193]
    v_pk_mul_f32 v[30:31], v[30:31], v[192:193]
    v_cvt_pk_bf16_f32 v28, v28, v29
    v_cvt_pk_bf16_f32 v29, v30, v31
    v_mfma_f32_16x16x32_bf16 a[176:179], v[136:139], v[184:187], a[176:179]
    ds_write_b64 v71, v[28:29] offset:128
    ds_read_b128 v[76:79], v64 offset:0
    ds_read_b128 v[80:83], v65 offset:512
    ds_read_b128 v[84:87], v66 offset:1024
    ds_read_b128 v[88:91], v67 offset:1536
    v_accvgpr_read_b32 v32, a160
    v_accvgpr_read_b32 v33, a161
    v_accvgpr_read_b32 v34, a162
    v_accvgpr_read_b32 v35, a163
    v_pk_mul_f32 v[32:33], v[32:33], v[192:193]
    v_pk_mul_f32 v[34:35], v[34:35], v[192:193]
    v_cvt_pk_bf16_f32 v32, v32, v33
    v_cvt_pk_bf16_f32 v33, v34, v35
    s_waitcnt lgkmcnt(15)
    v_mfma_f32_16x16x32_bf16 a[180:183], v[104:107], v[184:187], a[180:183]
    ds_write_b64 v68, v[32:33] offset:49152
    ds_read_b64_tr_b16 v[122:123], v252 offset:2304
    ds_read_b64_tr_b16 v[224:225], v251 offset:33280
    ds_read_b64_tr_b16 v[226:227], v251 offset:35328
    v_accvgpr_read_b32 v36, a164
    v_accvgpr_read_b32 v37, a165
    v_accvgpr_read_b32 v38, a166
    v_accvgpr_read_b32 v39, a167
    v_pk_mul_f32 v[36:37], v[36:37], v[192:193]
    v_mfma_f32_16x16x32_bf16 a[184:187], v[108:111], v[184:187], a[184:187]
    ds_read_b64_tr_b16 v[232:233], v251 offset:512
    s_waitcnt lgkmcnt(8)
    buffer_store_dwordx4 v[76:79], v254, s[16:19], s57 offen offset:0 nt
    s_waitcnt lgkmcnt(7)
    buffer_store_dwordx4 v[80:83], v254, s[16:19], s57 offen offset:1024 nt
    s_waitcnt lgkmcnt(6)
    buffer_store_dwordx4 v[84:87], v254, s[16:19], s57 offen offset:2048 nt
    s_waitcnt lgkmcnt(5)
    buffer_store_dwordx4 v[88:91], v254, s[16:19], s57 offen offset:3072 nt
    v_pk_mul_f32 v[38:39], v[38:39], v[192:193]
    v_cvt_pk_bf16_f32 v36, v36, v37
    v_cvt_pk_bf16_f32 v37, v38, v39
    v_accvgpr_read_b32 v40, a168
    v_accvgpr_read_b32 v41, a169
    v_accvgpr_read_b32 v42, a170
    v_accvgpr_read_b32 v43, a171
    v_pk_mul_f32 v[40:41], v[40:41], v[192:193]
    v_pk_mul_f32 v[42:43], v[42:43], v[192:193]
    v_cvt_pk_bf16_f32 v40, v40, v41
    v_cvt_pk_bf16_f32 v41, v42, v43
    v_mfma_f32_16x16x32_bf16 a[188:191], v[140:143], v[184:187], a[188:191]
    ds_write_b64 v69, v[36:37] offset:49152
    ds_write_b64 v70, v[40:41] offset:49152
    ds_read_b64_tr_b16 v[234:235], v251 offset:2560
    ds_read_b64_tr_b16 v[228:229], v252 offset:33280
    ds_read_b64_tr_b16 v[230:231], v252 offset:35328
    v_accvgpr_read_b32 v44, a172
    v_accvgpr_read_b32 v45, a173
    v_accvgpr_read_b32 v46, a174
    v_accvgpr_read_b32 v47, a175
    v_pk_mul_f32 v[44:45], v[44:45], v[192:193]
    v_pk_mul_f32 v[46:47], v[46:47], v[192:193]
    v_cvt_pk_bf16_f32 v44, v44, v45
    v_cvt_pk_bf16_f32 v45, v46, v47
    v_mfma_f32_16x16x32_bf16 a[192:195], v[112:115], v[196:199], a[192:195]
    ds_write_b64 v71, v[44:45] offset:49152
    ds_read_b64_tr_b16 v[124:125], v252 offset:512
    ds_read_b64_tr_b16 v[126:127], v252 offset:2560
    v_accvgpr_read_b32 v48, a176
    v_accvgpr_read_b32 v49, a177
    v_accvgpr_read_b32 v50, a178
    v_accvgpr_read_b32 v51, a179
    v_pk_mul_f32 v[48:49], v[48:49], v[192:193]
    v_pk_mul_f32 v[50:51], v[50:51], v[192:193]
    v_cvt_pk_bf16_f32 v48, v48, v49
    v_cvt_pk_bf16_f32 v49, v50, v51
    v_accvgpr_read_b32 v52, a180
    v_accvgpr_read_b32 v53, a181
    v_accvgpr_read_b32 v54, a182
    v_accvgpr_read_b32 v55, a183
    v_pk_mul_f32 v[52:53], v[52:53], v[192:193]
    v_pk_mul_f32 v[54:55], v[54:55], v[192:193]
    v_cvt_pk_bf16_f32 v52, v52, v53
    v_cvt_pk_bf16_f32 v53, v54, v55
    v_fma_f32 v200, v200, s26, v244
    v_fma_f32 v201, v201, s26, v244
    v_fma_f32 v202, v202, s26, v244
    v_fma_f32 v203, v203, s26, v244
    v_fma_f32 v208, v208, s26, v244
    v_fma_f32 v209, v209, s26, v244
    v_fma_f32 v210, v210, s26, v244
    v_fma_f32 v211, v211, s26, v244
    v_exp_f32 v200, v200
    v_exp_f32 v201, v201
    v_exp_f32 v202, v202
    v_exp_f32 v203, v203
    v_exp_f32 v208, v208
    v_exp_f32 v209, v209
    v_exp_f32 v210, v210
    v_exp_f32 v211, v211
    v_add_f32 v249, v200, v249
    v_add_f32 v249, v201, v249
    v_add_f32 v249, v202, v249
    v_add_f32 v249, v203, v249
    v_cvt_pk_bf16_f32 v200, v200, v201
    v_cvt_pk_bf16_f32 v201, v202, v203
    v_cvt_pk_bf16_f32 v202, v208, v209
    v_cvt_pk_bf16_f32 v203, v210, v211
    v_accvgpr_read_b32 v56, a184
    v_accvgpr_read_b32 v57, a185
    v_mfma_f32_16x16x32_bf16 a[192:195], v[236:239], v[200:203], a[192:195]
    ds_write_b64 v68, v[48:49] offset:49280
    ds_write_b64 v69, v[52:53] offset:49280
    ds_read_b64_tr_b16 v[128:129], v251 offset:33536
    ds_read_b64_tr_b16 v[130:131], v251 offset:35584
    ds_read_b64_tr_b16 v[132:133], v251 offset:768
    ds_read_b64_tr_b16 v[134:135], v251 offset:2816
    v_mfma_f32_16x16x32_bf16 a[196:199], v[212:215], v[196:199], a[196:199]
    ds_read_b64_tr_b16 v[96:97], v252 offset:33536
    v_accvgpr_read_b32 v58, a186
    v_accvgpr_read_b32 v59, a187
    v_add_f32 v249, v208, v249
    v_pk_mul_f32 v[56:57], v[56:57], v[192:193]
    v_pk_mul_f32 v[58:59], v[58:59], v[192:193]
    v_cvt_pk_bf16_f32 v56, v56, v57
    v_cvt_pk_bf16_f32 v57, v58, v59
    v_add_f32 v249, v209, v249
    v_add_f32 v249, v210, v249
    v_add_f32 v249, v211, v249
    v_mov_b32 v208, v249
    v_mfma_f32_16x16x32_bf16 a[196:199], v[116:119], v[200:203], a[196:199]
    ds_write_b64 v70, v[56:57] offset:49280
    v_permlane32_swap_b32 v249, v208
    v_add_f32 v249, v249, v208
    v_mov_b32 v208, v249
    v_accvgpr_read_b32 v60, a188
    v_accvgpr_read_b32 v61, a189
    v_permlane16_swap_b32 v249, v208
    v_add_f32 v249, v249, v208
    v_add_f32 v240, v240, v249
    v_rcp_f32 v208, v249
    v_accvgpr_read_b32 v62, a190
    v_accvgpr_read_b32 v63, a191
    v_pk_mul_f32 v[60:61], v[60:61], v[192:193]
    v_mov_b32 v209, v208
    v_pk_mul_f32 v[62:63], v[62:63], v[192:193]
    v_cvt_pk_bf16_f32 v60, v60, v61
    v_cvt_pk_bf16_f32 v61, v62, v63
    v_mfma_f32_16x16x32_bf16 a[200:203], v[216:219], v[196:199], a[200:203]
    ds_write_b64 v71, v[60:61] offset:49280
    ds_read_b128 v[76:79], v64 offset:49152
    ds_read_b128 v[80:83], v65 offset:49664
    ds_read_b128 v[84:87], v66 offset:50176
    ds_read_b128 v[88:91], v67 offset:50688
    v_mfma_f32_16x16x32_bf16 a[200:203], v[92:95], v[200:203], a[200:203]
    ds_read_b64_tr_b16 v[98:99], v252 offset:35584
    v_accvgpr_read_b32 v0, a192
    v_accvgpr_read_b32 v1, a193
    v_accvgpr_read_b32 v2, a194
    v_accvgpr_read_b32 v3, a195
    v_pk_mul_f32 v[0:1], v[0:1], v[208:209]
    v_pk_mul_f32 v[2:3], v[2:3], v[208:209]
    v_cvt_pk_bf16_f32 v0, v0, v1
    v_cvt_pk_bf16_f32 v1, v2, v3
    v_mfma_f32_16x16x32_bf16 a[204:207], v[220:223], v[196:199], a[204:207]
    ds_read_b64_tr_b16 v[100:101], v252 offset:768
    ds_read_b64_tr_b16 v[102:103], v252 offset:2816
    ds_write_b64 v68, v[0:1] offset:0
    ds_read_b64_tr_b16 v[136:137], v251 offset:40960
    ds_read_b64_tr_b16 v[138:139], v251 offset:43008
    s_waitcnt lgkmcnt(9)
    buffer_store_dwordx4 v[76:79], v254, s[16:19], s57 offen offset:256 nt
    s_waitcnt lgkmcnt(8)
    buffer_store_dwordx4 v[80:83], v254, s[16:19], s57 offen offset:1280 nt
    s_waitcnt lgkmcnt(7)
    buffer_store_dwordx4 v[84:87], v254, s[16:19], s57 offen offset:2304 nt
    s_waitcnt lgkmcnt(6)
    buffer_store_dwordx4 v[88:91], v254, s[16:19], s57 offen offset:3328 nt
    ds_read_b64_tr_b16 v[104:105], v251 offset:8192
    ds_read_b64_tr_b16 v[106:107], v251 offset:10240
    ds_read_b64_tr_b16 v[108:109], v252 offset:40960
    ds_read_b64_tr_b16 v[110:111], v252 offset:43008
    v_mfma_f32_16x16x32_bf16 a[204:207], v[120:123], v[200:203], a[204:207]
    ds_read_b64_tr_b16 v[140:141], v252 offset:8192
    ds_read_b64_tr_b16 v[142:143], v252 offset:10240
    v_accvgpr_read_b32 v4, a196
    v_accvgpr_read_b32 v5, a197
    v_accvgpr_read_b32 v6, a198
    v_accvgpr_read_b32 v7, a199
    v_pk_mul_f32 v[4:5], v[4:5], v[208:209]
    v_pk_mul_f32 v[6:7], v[6:7], v[208:209]
    v_cvt_pk_bf16_f32 v4, v4, v5
    v_cvt_pk_bf16_f32 v5, v6, v7
    v_mfma_f32_16x16x32_bf16 a[208:211], v[224:227], v[196:199], a[208:211]
    ds_write_b64 v69, v[4:5] offset:0
    ds_read_b64_tr_b16 v[112:113], v251 offset:41216
    ds_read_b64_tr_b16 v[114:115], v251 offset:43264
    v_mfma_f32_16x16x32_bf16 a[208:211], v[232:235], v[200:203], a[208:211]
    ds_read_b64_tr_b16 v[236:237], v251 offset:8448
    ds_read_b64_tr_b16 v[238:239], v251 offset:10496
    v_accvgpr_read_b32 v8, a200
    v_accvgpr_read_b32 v9, a201
    v_accvgpr_read_b32 v10, a202
    v_accvgpr_read_b32 v11, a203
    v_pk_mul_f32 v[8:9], v[8:9], v[208:209]
    v_pk_mul_f32 v[10:11], v[10:11], v[208:209]
    v_cvt_pk_bf16_f32 v8, v8, v9
    v_cvt_pk_bf16_f32 v9, v10, v11
    v_mfma_f32_16x16x32_bf16 a[212:215], v[228:231], v[196:199], a[212:215]
    ds_write_b64 v70, v[8:9] offset:0
    ds_read_b64_tr_b16 v[212:213], v252 offset:41216
    ds_read_b64_tr_b16 v[214:215], v252 offset:43264
    v_mfma_f32_16x16x32_bf16 a[212:215], v[124:127], v[200:203], a[212:215]
    ds_read_b64_tr_b16 v[116:117], v252 offset:8448
    ds_read_b64_tr_b16 v[118:119], v252 offset:10496
    v_accvgpr_read_b32 v12, a204
    v_accvgpr_read_b32 v13, a205
    v_accvgpr_read_b32 v14, a206
    v_accvgpr_read_b32 v15, a207
    v_pk_mul_f32 v[12:13], v[12:13], v[208:209]
    v_pk_mul_f32 v[14:15], v[14:15], v[208:209]
    v_cvt_pk_bf16_f32 v12, v12, v13
    v_cvt_pk_bf16_f32 v13, v14, v15
    v_mfma_f32_16x16x32_bf16 a[216:219], v[128:131], v[196:199], a[216:219]
    ds_write_b64 v71, v[12:13] offset:0
    ds_read_b64_tr_b16 v[216:217], v251 offset:41472
    ds_read_b64_tr_b16 v[218:219], v251 offset:43520
    v_mfma_f32_16x16x32_bf16 a[216:219], v[132:135], v[200:203], a[216:219]
    ds_read_b64_tr_b16 v[92:93], v251 offset:8704
    ds_read_b64_tr_b16 v[94:95], v251 offset:10752
    v_accvgpr_read_b32 v16, a208
    v_accvgpr_read_b32 v17, a209
    v_accvgpr_read_b32 v18, a210
    v_accvgpr_read_b32 v19, a211
    v_pk_mul_f32 v[16:17], v[16:17], v[208:209]
    v_pk_mul_f32 v[18:19], v[18:19], v[208:209]
    v_cvt_pk_bf16_f32 v16, v16, v17
    v_cvt_pk_bf16_f32 v17, v18, v19
    s_waitcnt lgkmcnt(15)
    v_mfma_f32_16x16x32_bf16 a[220:223], v[96:99], v[196:199], a[220:223]
    ds_write_b64 v68, v[16:17] offset:128
    ds_read_b64_tr_b16 v[220:221], v252 offset:41472
    ds_read_b64_tr_b16 v[222:223], v252 offset:43520
    v_mfma_f32_16x16x32_bf16 a[220:223], v[100:103], v[200:203], a[220:223]
    ds_read_b64_tr_b16 v[120:121], v252 offset:8704
    ds_read_b64_tr_b16 v[122:123], v252 offset:10752
    v_accvgpr_read_b32 v20, a212
    v_accvgpr_read_b32 v21, a213
    v_accvgpr_read_b32 v22, a214
    v_accvgpr_read_b32 v23, a215
    v_pk_mul_f32 v[20:21], v[20:21], v[208:209]
    v_pk_mul_f32 v[22:23], v[22:23], v[208:209]
    v_cvt_pk_bf16_f32 v20, v20, v21
    v_cvt_pk_bf16_f32 v21, v22, v23
    v_mfma_f32_16x16x32_bf16 a[224:227], v[136:139], v[196:199], a[224:227]
    ds_write_b64 v69, v[20:21] offset:128
    ds_read_b64_tr_b16 v[224:225], v251 offset:41728
    ds_read_b64_tr_b16 v[226:227], v251 offset:43776
    v_mfma_f32_16x16x32_bf16 a[224:227], v[104:107], v[200:203], a[224:227]
    ds_read_b64_tr_b16 v[232:233], v251 offset:8960
    ds_read_b64_tr_b16 v[234:235], v251 offset:11008
    v_accvgpr_read_b32 v24, a216
    v_accvgpr_read_b32 v25, a217
    v_accvgpr_read_b32 v26, a218
    v_accvgpr_read_b32 v27, a219
    v_pk_mul_f32 v[24:25], v[24:25], v[208:209]
    v_pk_mul_f32 v[26:27], v[26:27], v[208:209]
    v_cvt_pk_bf16_f32 v24, v24, v25
    v_cvt_pk_bf16_f32 v25, v26, v27
    v_mfma_f32_16x16x32_bf16 a[228:231], v[108:111], v[196:199], a[228:231]
    ds_write_b64 v70, v[24:25] offset:128
    ds_read_b64_tr_b16 v[228:229], v252 offset:41728
    ds_read_b64_tr_b16 v[230:231], v252 offset:43776
    v_mfma_f32_16x16x32_bf16 a[228:231], v[140:143], v[200:203], a[228:231]
    ds_read_b64_tr_b16 v[124:125], v252 offset:8960
    ds_read_b64_tr_b16 v[126:127], v252 offset:11008
    v_accvgpr_read_b32 v28, a220
    v_accvgpr_read_b32 v29, a221
    v_accvgpr_read_b32 v30, a222
    v_accvgpr_read_b32 v31, a223
    v_pk_mul_f32 v[28:29], v[28:29], v[208:209]
    v_pk_mul_f32 v[30:31], v[30:31], v[208:209]
    v_cvt_pk_bf16_f32 v28, v28, v29
    v_cvt_pk_bf16_f32 v29, v30, v31
    s_waitcnt lgkmcnt(15)
    v_mfma_f32_16x16x32_bf16 a[232:235], v[112:115], v[196:199], a[232:235]
    ds_write_b64 v71, v[28:29] offset:128
    ds_read_b128 v[76:79], v64 offset:0
    ds_read_b128 v[80:83], v65 offset:512
    ds_read_b128 v[84:87], v66 offset:1024
    ds_read_b128 v[88:91], v67 offset:1536
    v_mfma_f32_16x16x32_bf16 a[232:235], v[236:239], v[200:203], a[232:235]
    v_accvgpr_read_b32 v32, a224
    v_accvgpr_read_b32 v33, a225
    v_accvgpr_read_b32 v34, a226
    v_accvgpr_read_b32 v35, a227
    v_pk_mul_f32 v[32:33], v[32:33], v[208:209]
    v_pk_mul_f32 v[34:35], v[34:35], v[208:209]
    v_cvt_pk_bf16_f32 v32, v32, v33
    v_cvt_pk_bf16_f32 v33, v34, v35
    v_mfma_f32_16x16x32_bf16 a[236:239], v[212:215], v[196:199], a[236:239]
    ds_write_b64 v68, v[32:33] offset:49152
    v_accvgpr_read_b32 v36, a228
    v_mfma_f32_16x16x32_bf16 a[236:239], v[116:119], v[200:203], a[236:239]
    v_accvgpr_read_b32 v37, a229
    v_accvgpr_read_b32 v38, a230
    v_accvgpr_read_b32 v39, a231
    v_accvgpr_read_b32 v40, a232
    v_pk_mul_f32 v[36:37], v[36:37], v[208:209]
    v_pk_mul_f32 v[38:39], v[38:39], v[208:209]
    v_mfma_f32_16x16x32_bf16 a[240:243], v[216:219], v[196:199], a[240:243]
    s_waitcnt lgkmcnt(4)
    buffer_store_dwordx4 v[76:79], v254, s[16:19], s58 offen offset:0 nt
    s_waitcnt lgkmcnt(3)
    buffer_store_dwordx4 v[80:83], v254, s[16:19], s58 offen offset:1024 nt
    s_waitcnt lgkmcnt(2)
    buffer_store_dwordx4 v[84:87], v254, s[16:19], s58 offen offset:2048 nt
    s_waitcnt lgkmcnt(1)
    buffer_store_dwordx4 v[88:91], v254, s[16:19], s58 offen offset:3072 nt
    v_cvt_pk_bf16_f32 v36, v36, v37
    v_cvt_pk_bf16_f32 v37, v38, v39
    v_mfma_f32_16x16x32_bf16 a[240:243], v[92:95], v[200:203], a[240:243]
    ds_write_b64 v69, v[36:37] offset:49152
    v_accvgpr_read_b32 v41, a233
    v_accvgpr_read_b32 v42, a234
    v_accvgpr_read_b32 v43, a235
    v_pk_mul_f32 v[40:41], v[40:41], v[208:209]
    v_pk_mul_f32 v[42:43], v[42:43], v[208:209]
    v_cvt_pk_bf16_f32 v40, v40, v41
    v_cvt_pk_bf16_f32 v41, v42, v43
    v_mfma_f32_16x16x32_bf16 a[244:247], v[220:223], v[196:199], a[244:247]
    ds_write_b64 v70, v[40:41] offset:49152
    v_accvgpr_read_b32 v44, a236
    v_mfma_f32_16x16x32_bf16 a[244:247], v[120:123], v[200:203], a[244:247]
    v_accvgpr_read_b32 v45, a237
    v_accvgpr_read_b32 v46, a238
    v_accvgpr_read_b32 v47, a239
    v_accvgpr_read_b32 v48, a240
    v_pk_mul_f32 v[44:45], v[44:45], v[208:209]
    v_pk_mul_f32 v[46:47], v[46:47], v[208:209]
    v_cvt_pk_bf16_f32 v44, v44, v45
    v_cvt_pk_bf16_f32 v45, v46, v47
    v_mfma_f32_16x16x32_bf16 a[248:251], v[224:227], v[196:199], a[248:251]
    ds_write_b64 v71, v[44:45] offset:49152
    v_accvgpr_read_b32 v49, a241
    v_mfma_f32_16x16x32_bf16 a[248:251], v[232:235], v[200:203], a[248:251]
    v_accvgpr_read_b32 v50, a242
    v_accvgpr_read_b32 v51, a243
    v_accvgpr_read_b32 v52, a244
    v_accvgpr_read_b32 v53, a245
    v_pk_mul_f32 v[48:49], v[48:49], v[208:209]
    v_pk_mul_f32 v[50:51], v[50:51], v[208:209]
    v_cvt_pk_bf16_f32 v48, v48, v49
    v_cvt_pk_bf16_f32 v49, v50, v51
    v_mfma_f32_16x16x32_bf16 a[252:255], v[228:231], v[196:199], a[252:255]
    ds_write_b64 v68, v[48:49] offset:49280
    v_accvgpr_read_b32 v54, a246
    v_mfma_f32_16x16x32_bf16 a[252:255], v[124:127], v[200:203], a[252:255]
    v_accvgpr_read_b32 v55, a247
    v_accvgpr_read_b32 v56, a248
    v_accvgpr_read_b32 v57, a249
    v_accvgpr_read_b32 v58, a250
    v_pk_mul_f32 v[52:53], v[52:53], v[208:209]
    v_pk_mul_f32 v[54:55], v[54:55], v[208:209]
    v_cvt_pk_bf16_f32 v52, v52, v53
    v_cvt_pk_bf16_f32 v53, v54, v55
    v_accvgpr_read_b32 v59, a251
    v_pk_mul_f32 v[56:57], v[56:57], v[208:209]
    v_pk_mul_f32 v[58:59], v[58:59], v[208:209]
    v_cvt_pk_bf16_f32 v56, v56, v57
    v_cvt_pk_bf16_f32 v57, v58, v59
    ds_write_b64 v69, v[52:53] offset:49280
    ds_write_b64 v70, v[56:57] offset:49280
    v_accvgpr_read_b32 v60, a252
    v_accvgpr_read_b32 v61, a253
    v_accvgpr_read_b32 v62, a254
    v_accvgpr_read_b32 v63, a255
    v_pk_mul_f32 v[60:61], v[60:61], v[208:209]
    v_pk_mul_f32 v[62:63], v[62:63], v[208:209]
    v_cvt_pk_bf16_f32 v60, v60, v61
    v_cvt_pk_bf16_f32 v61, v62, v63
    ds_write_b64 v71, v[60:61] offset:49280
    ds_read_b128 v[76:79], v64 offset:49152
    ds_read_b128 v[80:83], v65 offset:49664
    ds_read_b128 v[84:87], v66 offset:50176
    ds_read_b128 v[88:91], v67 offset:50688
    s_waitcnt lgkmcnt(3)
    buffer_store_dwordx4 v[76:79], v254, s[16:19], s58 offen offset:256 nt
    s_waitcnt lgkmcnt(2)
    buffer_store_dwordx4 v[80:83], v254, s[16:19], s58 offen offset:1280 nt
    s_waitcnt lgkmcnt(1)
    buffer_store_dwordx4 v[84:87], v254, s[16:19], s58 offen offset:2304 nt
    s_waitcnt lgkmcnt(0)
    buffer_store_dwordx4 v[88:91], v254, s[16:19], s58 offen offset:3328 nt
    s_mov_b32 s30, 0x5f800000
    v_cmp_ngt_f32 vcc, s30, v240
    s_nop 1
    s_cmp_lg_u64 vcc, 0
    s_cselect_b32 s31, 1, 0
    v_mov_b32 v212, s31
    v_mov_b32 v213, s22
    v_and_b32 v214, 3, v255
    v_lshlrev_b32 v214, 12, v214
    ds_write_b32 v213, v212 offset:0
    s_waitcnt lgkmcnt(0)
    s_barrier
    ds_read_b32 v212, v214 offset:0
    s_waitcnt lgkmcnt(0)
    v_cmp_ne_u32 vcc, 0, v212
    s_nop 1
    s_andn2_b64 vcc, vcc, s[42:43]
    s_cmp_lg_u64 vcc, 0
    s_cbranch_scc1 L_fallback
    s_endpgm
L_fallback:
    s_mov_b64 s[42:43], -1
    s_mov_b32 s20, 0
    s_mov_b32 s27, 32
    v_mov_b32 v240, 0xff800000
    v_mov_b32 v241, 0xff800000
    v_mov_b32 v242, 0xff800000
    v_mov_b32 v243, 0xff800000
    v_mov_b32 v244, 0xff800000
    s_and_b32 s30, s29, 1
    s_lshr_b32 s31, s29, 1
    s_lshl_b32 s32, s30, 13
    s_lshl_b32 s33, s31, 8
    s_add_u32 s32, s32, s33
    s_lshl_b32 s30, s30, 1
    s_waitcnt vmcnt(0)
    v_and_b32 v212, 3, v255
    v_xor_b32 v212, s30, v212
    v_lshlrev_b32 v212, 4, v212
    v_lshrrev_b32 v213, 4, v255
    v_lshl_add_u32 v212, v213, 6, v212
    v_bfe_u32 v213, v255, 2, 1
    v_lshl_add_u32 v212, v213, 9, v212
    v_bfe_u32 v213, v255, 3, 1
    v_lshl_add_u32 v212, v213, 12, v212
    v_add_u32 v254, s32, v212
    v_and_b32 v212, 7, v255
    v_add_u32 v212, s40, v212
    v_lshlrev_b32 v212, 9, v212
    v_bfe_u32 v213, v255, 3, 1
    v_lshl_add_u32 v212, v213, 6, v212
    v_lshrrev_b32 v213, 4, v255
    v_lshl_add_u32 v236, v213, 4, v212
    v_bfe_u32 v212, v255, 2, 2
    v_add_u32 v212, s40, v212
    v_lshlrev_b32 v212, 9, v212
    v_lshrrev_b32 v213, 4, v255
    v_lshl_add_u32 v212, v213, 6, v212
    v_and_b32 v213, 3, v255
    v_lshl_add_u32 v238, v213, 4, v212
    v_xor_b32 v239, 32, v238
    buffer_load_dwordx4 v[64:67], v236, s[4:7], s54 offen offset:0 nt
    s_add_u32 s31, s54, 4096
    buffer_load_dwordx4 v[68:71], v236, s[4:7], s31 offen offset:0 nt
    buffer_load_dwordx4 v[72:75], v236, s[4:7], s54 offen offset:128 nt
    s_add_u32 s31, s54, 4096
    buffer_load_dwordx4 v[76:79], v236, s[4:7], s31 offen offset:128 nt
    buffer_load_dwordx4 v[80:83], v236, s[4:7], s54 offen offset:256 nt
    s_add_u32 s31, s54, 4096
    buffer_load_dwordx4 v[84:87], v236, s[4:7], s31 offen offset:256 nt
    buffer_load_dwordx4 v[88:91], v236, s[4:7], s54 offen offset:384 nt
    s_add_u32 s31, s54, 4096
    buffer_load_dwordx4 v[92:95], v236, s[4:7], s31 offen offset:384 nt
    buffer_load_dwordx4 v[96:99], v236, s[4:7], s55 offen offset:0 nt
    s_add_u32 s31, s55, 4096
    buffer_load_dwordx4 v[100:103], v236, s[4:7], s31 offen offset:0 nt
    buffer_load_dwordx4 v[104:107], v236, s[4:7], s55 offen offset:128 nt
    s_add_u32 s31, s55, 4096
    buffer_load_dwordx4 v[108:111], v236, s[4:7], s31 offen offset:128 nt
    buffer_load_dwordx4 v[112:115], v236, s[4:7], s55 offen offset:256 nt
    s_add_u32 s31, s55, 4096
    buffer_load_dwordx4 v[116:119], v236, s[4:7], s31 offen offset:256 nt
    buffer_load_dwordx4 v[120:123], v236, s[4:7], s55 offen offset:384 nt
    s_add_u32 s31, s55, 4096
    buffer_load_dwordx4 v[124:127], v236, s[4:7], s31 offen offset:384 nt
    buffer_load_dwordx4 v[128:131], v236, s[4:7], s56 offen offset:0 nt
    s_add_u32 s31, s56, 4096
    buffer_load_dwordx4 v[132:135], v236, s[4:7], s31 offen offset:0 nt
    buffer_load_dwordx4 v[136:139], v236, s[4:7], s56 offen offset:128 nt
    s_add_u32 s31, s56, 4096
    buffer_load_dwordx4 v[140:143], v236, s[4:7], s31 offen offset:128 nt
    s_add_u32 m0, s34, 0
    s_mov_b32 s30, 16640
    buffer_load_dwordx4 v238, s[4:7], s30 offen offset:0 nt lds
    s_add_u32 m0, s34, 1024
    s_mov_b32 s30, 18688
    buffer_load_dwordx4 v239, s[4:7], s30 offen offset:0 nt lds
    s_add_u32 m0, s34, 2048
    s_mov_b32 s30, 20736
    buffer_load_dwordx4 v238, s[4:7], s30 offen offset:0 nt lds
    s_add_u32 m0, s34, 3072
    s_mov_b32 s30, 22784
    buffer_load_dwordx4 v239, s[4:7], s30 offen offset:0 nt lds
    s_add_u32 m0, s34, 4096
    s_mov_b32 s30, 24576
    buffer_load_dwordx4 v238, s[4:7], s30 offen offset:0 nt lds
    s_add_u32 m0, s34, 5120
    s_mov_b32 s30, 26624
    buffer_load_dwordx4 v239, s[4:7], s30 offen offset:0 nt lds
    s_add_u32 m0, s34, 6144
    s_mov_b32 s30, 28672
    buffer_load_dwordx4 v238, s[4:7], s30 offen offset:0 nt lds
    s_add_u32 m0, s34, 7168
    s_mov_b32 s30, 30720
    buffer_load_dwordx4 v239, s[4:7], s30 offen offset:0 nt lds
    s_add_u32 m0, s34, 8192
    s_mov_b32 s30, 24832
    buffer_load_dwordx4 v238, s[4:7], s30 offen offset:0 nt lds
    s_add_u32 m0, s34, 9216
    s_mov_b32 s30, 26880
    buffer_load_dwordx4 v239, s[4:7], s30 offen offset:0 nt lds
    s_add_u32 m0, s34, 10240
    s_mov_b32 s30, 28928
    buffer_load_dwordx4 v238, s[4:7], s30 offen offset:0 nt lds
    s_add_u32 m0, s34, 11264
    s_mov_b32 s30, 30976
    buffer_load_dwordx4 v239, s[4:7], s30 offen offset:0 nt lds
    s_add_u32 m0, s34, 12288
    s_mov_b32 s30, 32768
    buffer_load_dwordx4 v238, s[4:7], s30 offen offset:0 nt lds
    s_add_u32 m0, s34, 13312
    s_mov_b32 s30, 34816
    buffer_load_dwordx4 v239, s[4:7], s30 offen offset:0 nt lds
    s_add_u32 m0, s34, 14336
    s_mov_b32 s30, 36864
    buffer_load_dwordx4 v238, s[4:7], s30 offen offset:0 nt lds
    s_add_u32 m0, s34, 15360
    s_mov_b32 s30, 38912
    buffer_load_dwordx4 v239, s[4:7], s30 offen offset:0 nt lds
    s_add_u32 m0, s34, 16384
    s_mov_b32 s30, 33024
    buffer_load_dwordx4 v238, s[4:7], s30 offen offset:0 nt lds
    s_add_u32 m0, s34, 17408
    s_mov_b32 s30, 35072
    buffer_load_dwordx4 v239, s[4:7], s30 offen offset:0 nt lds
    s_add_u32 m0, s34, 18432
    s_mov_b32 s30, 37120
    buffer_load_dwordx4 v238, s[4:7], s30 offen offset:0 nt lds
    s_add_u32 m0, s34, 19456
    s_mov_b32 s30, 39168
    buffer_load_dwordx4 v239, s[4:7], s30 offen offset:0 nt lds
    s_waitcnt vmcnt(0)
    v_mov_b32 v220, v64
    v_mov_b32 v221, v65
    v_mov_b32 v222, v66
    v_mov_b32 v223, v67
    v_mov_b32_dpp v64, v68 row_ror:8 row_mask:0xf bank_mask:0xc
    v_mov_b32_dpp v65, v69 row_ror:8 row_mask:0xf bank_mask:0xc
    v_mov_b32_dpp v66, v70 row_ror:8 row_mask:0xf bank_mask:0xc
    v_mov_b32_dpp v67, v71 row_ror:8 row_mask:0xf bank_mask:0xc
    v_mov_b32_dpp v68, v220 row_ror:8 row_mask:0xf bank_mask:0x3
    v_mov_b32_dpp v69, v221 row_ror:8 row_mask:0xf bank_mask:0x3
    v_mov_b32_dpp v70, v222 row_ror:8 row_mask:0xf bank_mask:0x3
    v_mov_b32_dpp v71, v223 row_ror:8 row_mask:0xf bank_mask:0x3
    v_mov_b32 v220, v72
    v_mov_b32 v221, v73
    v_mov_b32 v222, v74
    v_mov_b32 v223, v75
    v_mov_b32_dpp v72, v76 row_ror:8 row_mask:0xf bank_mask:0xc
    v_mov_b32_dpp v73, v77 row_ror:8 row_mask:0xf bank_mask:0xc
    v_mov_b32_dpp v74, v78 row_ror:8 row_mask:0xf bank_mask:0xc
    v_mov_b32_dpp v75, v79 row_ror:8 row_mask:0xf bank_mask:0xc
    v_mov_b32_dpp v76, v220 row_ror:8 row_mask:0xf bank_mask:0x3
    v_mov_b32_dpp v77, v221 row_ror:8 row_mask:0xf bank_mask:0x3
    v_mov_b32_dpp v78, v222 row_ror:8 row_mask:0xf bank_mask:0x3
    v_mov_b32_dpp v79, v223 row_ror:8 row_mask:0xf bank_mask:0x3
    v_mov_b32 v220, v80
    v_mov_b32 v221, v81
    v_mov_b32 v222, v82
    v_mov_b32 v223, v83
    v_mov_b32_dpp v80, v84 row_ror:8 row_mask:0xf bank_mask:0xc
    v_mov_b32_dpp v81, v85 row_ror:8 row_mask:0xf bank_mask:0xc
    v_mov_b32_dpp v82, v86 row_ror:8 row_mask:0xf bank_mask:0xc
    v_mov_b32_dpp v83, v87 row_ror:8 row_mask:0xf bank_mask:0xc
    v_mov_b32_dpp v84, v220 row_ror:8 row_mask:0xf bank_mask:0x3
    v_mov_b32_dpp v85, v221 row_ror:8 row_mask:0xf bank_mask:0x3
    v_mov_b32_dpp v86, v222 row_ror:8 row_mask:0xf bank_mask:0x3
    v_mov_b32_dpp v87, v223 row_ror:8 row_mask:0xf bank_mask:0x3
    v_mov_b32 v220, v88
    v_mov_b32 v221, v89
    v_mov_b32 v222, v90
    v_mov_b32 v223, v91
    v_mov_b32_dpp v88, v92 row_ror:8 row_mask:0xf bank_mask:0xc
    v_mov_b32_dpp v89, v93 row_ror:8 row_mask:0xf bank_mask:0xc
    v_mov_b32_dpp v90, v94 row_ror:8 row_mask:0xf bank_mask:0xc
    v_mov_b32_dpp v91, v95 row_ror:8 row_mask:0xf bank_mask:0xc
    v_mov_b32_dpp v92, v220 row_ror:8 row_mask:0xf bank_mask:0x3
    v_mov_b32_dpp v93, v221 row_ror:8 row_mask:0xf bank_mask:0x3
    v_mov_b32_dpp v94, v222 row_ror:8 row_mask:0xf bank_mask:0x3
    v_mov_b32_dpp v95, v223 row_ror:8 row_mask:0xf bank_mask:0x3
    v_mov_b32 v220, v96
    v_mov_b32 v221, v97
    v_mov_b32 v222, v98
    v_mov_b32 v223, v99
    v_mov_b32_dpp v96, v100 row_ror:8 row_mask:0xf bank_mask:0xc
    v_mov_b32_dpp v97, v101 row_ror:8 row_mask:0xf bank_mask:0xc
    v_mov_b32_dpp v98, v102 row_ror:8 row_mask:0xf bank_mask:0xc
    v_mov_b32_dpp v99, v103 row_ror:8 row_mask:0xf bank_mask:0xc
    v_mov_b32_dpp v100, v220 row_ror:8 row_mask:0xf bank_mask:0x3
    v_mov_b32_dpp v101, v221 row_ror:8 row_mask:0xf bank_mask:0x3
    v_mov_b32_dpp v102, v222 row_ror:8 row_mask:0xf bank_mask:0x3
    v_mov_b32_dpp v103, v223 row_ror:8 row_mask:0xf bank_mask:0x3
    v_mov_b32 v220, v104
    v_mov_b32 v221, v105
    v_mov_b32 v222, v106
    v_mov_b32 v223, v107
    v_mov_b32_dpp v104, v108 row_ror:8 row_mask:0xf bank_mask:0xc
    v_mov_b32_dpp v105, v109 row_ror:8 row_mask:0xf bank_mask:0xc
    v_mov_b32_dpp v106, v110 row_ror:8 row_mask:0xf bank_mask:0xc
    v_mov_b32_dpp v107, v111 row_ror:8 row_mask:0xf bank_mask:0xc
    v_mov_b32_dpp v108, v220 row_ror:8 row_mask:0xf bank_mask:0x3
    v_mov_b32_dpp v109, v221 row_ror:8 row_mask:0xf bank_mask:0x3
    v_mov_b32_dpp v110, v222 row_ror:8 row_mask:0xf bank_mask:0x3
    v_mov_b32_dpp v111, v223 row_ror:8 row_mask:0xf bank_mask:0x3
    v_mov_b32 v220, v112
    v_mov_b32 v221, v113
    v_mov_b32 v222, v114
    v_mov_b32 v223, v115
    v_mov_b32_dpp v112, v116 row_ror:8 row_mask:0xf bank_mask:0xc
    v_mov_b32_dpp v113, v117 row_ror:8 row_mask:0xf bank_mask:0xc
    v_mov_b32_dpp v114, v118 row_ror:8 row_mask:0xf bank_mask:0xc
    v_mov_b32_dpp v115, v119 row_ror:8 row_mask:0xf bank_mask:0xc
    v_mov_b32_dpp v116, v220 row_ror:8 row_mask:0xf bank_mask:0x3
    v_mov_b32_dpp v117, v221 row_ror:8 row_mask:0xf bank_mask:0x3
    v_mov_b32_dpp v118, v222 row_ror:8 row_mask:0xf bank_mask:0x3
    v_mov_b32_dpp v119, v223 row_ror:8 row_mask:0xf bank_mask:0x3
    v_mov_b32 v220, v120
    v_mov_b32 v221, v121
    v_mov_b32 v222, v122
    v_mov_b32 v223, v123
    v_mov_b32_dpp v120, v124 row_ror:8 row_mask:0xf bank_mask:0xc
    v_mov_b32_dpp v121, v125 row_ror:8 row_mask:0xf bank_mask:0xc
    v_mov_b32_dpp v122, v126 row_ror:8 row_mask:0xf bank_mask:0xc
    v_mov_b32_dpp v123, v127 row_ror:8 row_mask:0xf bank_mask:0xc
    v_mov_b32_dpp v124, v220 row_ror:8 row_mask:0xf bank_mask:0x3
    v_mov_b32_dpp v125, v221 row_ror:8 row_mask:0xf bank_mask:0x3
    v_mov_b32_dpp v126, v222 row_ror:8 row_mask:0xf bank_mask:0x3
    v_mov_b32_dpp v127, v223 row_ror:8 row_mask:0xf bank_mask:0x3
    v_mov_b32 v220, v128
    v_mov_b32 v221, v129
    v_mov_b32 v222, v130
    v_mov_b32 v223, v131
    v_mov_b32_dpp v128, v132 row_ror:8 row_mask:0xf bank_mask:0xc
    v_mov_b32_dpp v129, v133 row_ror:8 row_mask:0xf bank_mask:0xc
    v_mov_b32_dpp v130, v134 row_ror:8 row_mask:0xf bank_mask:0xc
    v_mov_b32_dpp v131, v135 row_ror:8 row_mask:0xf bank_mask:0xc
    v_mov_b32_dpp v132, v220 row_ror:8 row_mask:0xf bank_mask:0x3
    v_mov_b32_dpp v133, v221 row_ror:8 row_mask:0xf bank_mask:0x3
    v_mov_b32_dpp v134, v222 row_ror:8 row_mask:0xf bank_mask:0x3
    v_mov_b32_dpp v135, v223 row_ror:8 row_mask:0xf bank_mask:0x3
    v_mov_b32 v220, v136
    v_mov_b32 v221, v137
    v_mov_b32 v222, v138
    v_mov_b32 v223, v139
    v_mov_b32_dpp v136, v140 row_ror:8 row_mask:0xf bank_mask:0xc
    v_mov_b32_dpp v137, v141 row_ror:8 row_mask:0xf bank_mask:0xc
    v_mov_b32_dpp v138, v142 row_ror:8 row_mask:0xf bank_mask:0xc
    v_mov_b32_dpp v139, v143 row_ror:8 row_mask:0xf bank_mask:0xc
    v_mov_b32_dpp v140, v220 row_ror:8 row_mask:0xf bank_mask:0x3
    v_mov_b32_dpp v141, v221 row_ror:8 row_mask:0xf bank_mask:0x3
    v_mov_b32_dpp v142, v222 row_ror:8 row_mask:0xf bank_mask:0x3
    v_mov_b32_dpp v143, v223 row_ror:8 row_mask:0xf bank_mask:0x3
L_fbloop:
    s_barrier
    s_mov_b32 m0, s22
    s_nop 0
    buffer_load_dwordx4 v254, s[8:11], s20 offen offset:0 lds
    buffer_load_dwordx4 v254, s[8:11], s20 offen offset:1024 lds
    buffer_load_dwordx4 v254, s[8:11], s20 offen offset:2048 lds
    buffer_load_dwordx4 v254, s[8:11], s20 offen offset:3072 lds
    s_add_u32 s20, s20, 16384
    s_waitcnt vmcnt(0)
    s_barrier
    ds_read_b128 v[212:215], v250 offset:0
    ds_read_b128 v[216:219], v250 offset:2048
    ds_read_b128 v[220:223], v253 offset:4096
    ds_read_b128 v[224:227], v253 offset:12288
    s_waitcnt lgkmcnt(0)
    v_mfma_f32_16x16x32_bf16 v[144:147], v[212:215], v[64:67], 0
    v_mfma_f32_16x16x32_bf16 v[152:155], v[216:219], v[64:67], 0
    v_mfma_f32_16x16x32_bf16 v[156:159], v[212:215], v[96:99], 0
    v_mfma_f32_16x16x32_bf16 v[164:167], v[216:219], v[96:99], 0
    v_mfma_f32_16x16x32_bf16 v[168:171], v[212:215], v[128:131], 0
    v_mfma_f32_16x16x32_bf16 v[176:179], v[216:219], v[128:131], 0
    v_mfma_f32_16x16x32_bf16 v[180:183], v[212:215], v[220:223], 0
    v_mfma_f32_16x16x32_bf16 v[188:191], v[216:219], v[220:223], 0
    v_mfma_f32_16x16x32_bf16 v[196:199], v[212:215], v[224:227], 0
    v_mfma_f32_16x16x32_bf16 v[204:207], v[216:219], v[224:227], 0
    s_nop 3
    ds_read_b128 v[212:215], v250 offset:256
    ds_read_b128 v[216:219], v250 offset:2304
    ds_read_b128 v[220:223], v253 offset:4352
    ds_read_b128 v[224:227], v253 offset:12544
    s_waitcnt lgkmcnt(0)
    v_mfma_f32_16x16x32_bf16 v[144:147], v[212:215], v[68:71], v[144:147]
    v_mfma_f32_16x16x32_bf16 v[152:155], v[216:219], v[68:71], v[152:155]
    v_mfma_f32_16x16x32_bf16 v[156:159], v[212:215], v[100:103], v[156:159]
    v_mfma_f32_16x16x32_bf16 v[164:167], v[216:219], v[100:103], v[164:167]
    v_mfma_f32_16x16x32_bf16 v[168:171], v[212:215], v[132:135], v[168:171]
    v_mfma_f32_16x16x32_bf16 v[176:179], v[216:219], v[132:135], v[176:179]
    v_mfma_f32_16x16x32_bf16 v[180:183], v[212:215], v[220:223], v[180:183]
    v_mfma_f32_16x16x32_bf16 v[188:191], v[216:219], v[220:223], v[188:191]
    v_mfma_f32_16x16x32_bf16 v[196:199], v[212:215], v[224:227], v[196:199]
    v_mfma_f32_16x16x32_bf16 v[204:207], v[216:219], v[224:227], v[204:207]
    s_nop 3
    ds_read_b128 v[212:215], v250 offset:512
    ds_read_b128 v[216:219], v250 offset:2560
    ds_read_b128 v[220:223], v253 offset:4608
    ds_read_b128 v[224:227], v253 offset:12800
    s_waitcnt lgkmcnt(0)
    v_mfma_f32_16x16x32_bf16 v[144:147], v[212:215], v[72:75], v[144:147]
    v_mfma_f32_16x16x32_bf16 v[152:155], v[216:219], v[72:75], v[152:155]
    v_mfma_f32_16x16x32_bf16 v[156:159], v[212:215], v[104:107], v[156:159]
    v_mfma_f32_16x16x32_bf16 v[164:167], v[216:219], v[104:107], v[164:167]
    v_mfma_f32_16x16x32_bf16 v[168:171], v[212:215], v[136:139], v[168:171]
    v_mfma_f32_16x16x32_bf16 v[176:179], v[216:219], v[136:139], v[176:179]
    v_mfma_f32_16x16x32_bf16 v[180:183], v[212:215], v[220:223], v[180:183]
    v_mfma_f32_16x16x32_bf16 v[188:191], v[216:219], v[220:223], v[188:191]
    v_mfma_f32_16x16x32_bf16 v[196:199], v[212:215], v[224:227], v[196:199]
    v_mfma_f32_16x16x32_bf16 v[204:207], v[216:219], v[224:227], v[204:207]
    s_nop 3
    ds_read_b128 v[212:215], v250 offset:768
    ds_read_b128 v[216:219], v250 offset:2816
    ds_read_b128 v[220:223], v253 offset:4864
    ds_read_b128 v[224:227], v253 offset:13056
    s_waitcnt lgkmcnt(0)
    v_mfma_f32_16x16x32_bf16 v[144:147], v[212:215], v[76:79], v[144:147]
    v_mfma_f32_16x16x32_bf16 v[152:155], v[216:219], v[76:79], v[152:155]
    v_mfma_f32_16x16x32_bf16 v[156:159], v[212:215], v[108:111], v[156:159]
    v_mfma_f32_16x16x32_bf16 v[164:167], v[216:219], v[108:111], v[164:167]
    v_mfma_f32_16x16x32_bf16 v[168:171], v[212:215], v[140:143], v[168:171]
    v_mfma_f32_16x16x32_bf16 v[176:179], v[216:219], v[140:143], v[176:179]
    v_mfma_f32_16x16x32_bf16 v[180:183], v[212:215], v[220:223], v[180:183]
    v_mfma_f32_16x16x32_bf16 v[188:191], v[216:219], v[220:223], v[188:191]
    v_mfma_f32_16x16x32_bf16 v[196:199], v[212:215], v[224:227], v[196:199]
    v_mfma_f32_16x16x32_bf16 v[204:207], v[216:219], v[224:227], v[204:207]
    s_nop 3
    ds_read_b128 v[212:215], v250 offset:8192
    ds_read_b128 v[216:219], v250 offset:10240
    ds_read_b128 v[220:223], v253 offset:0
    ds_read_b128 v[224:227], v253 offset:8192
    ds_read_b128 v[228:231], v253 offset:16384
    s_waitcnt lgkmcnt(0)
    v_mfma_f32_16x16x32_bf16 v[144:147], v[212:215], v[80:83], v[144:147]
    v_mfma_f32_16x16x32_bf16 v[152:155], v[216:219], v[80:83], v[152:155]
    v_mfma_f32_16x16x32_bf16 v[156:159], v[212:215], v[112:115], v[156:159]
    v_mfma_f32_16x16x32_bf16 v[164:167], v[216:219], v[112:115], v[164:167]
    v_mfma_f32_16x16x32_bf16 v[168:171], v[212:215], v[220:223], v[168:171]
    v_mfma_f32_16x16x32_bf16 v[176:179], v[216:219], v[220:223], v[176:179]
    v_mfma_f32_16x16x32_bf16 v[180:183], v[212:215], v[224:227], v[180:183]
    v_mfma_f32_16x16x32_bf16 v[188:191], v[216:219], v[224:227], v[188:191]
    v_mfma_f32_16x16x32_bf16 v[196:199], v[212:215], v[228:231], v[196:199]
    v_mfma_f32_16x16x32_bf16 v[204:207], v[216:219], v[228:231], v[204:207]
    s_nop 3
    ds_read_b128 v[212:215], v250 offset:8448
    ds_read_b128 v[216:219], v250 offset:10496
    ds_read_b128 v[220:223], v253 offset:256
    ds_read_b128 v[224:227], v253 offset:8448
    ds_read_b128 v[228:231], v253 offset:16640
    s_waitcnt lgkmcnt(0)
    v_mfma_f32_16x16x32_bf16 v[144:147], v[212:215], v[84:87], v[144:147]
    v_mfma_f32_16x16x32_bf16 v[152:155], v[216:219], v[84:87], v[152:155]
    v_mfma_f32_16x16x32_bf16 v[156:159], v[212:215], v[116:119], v[156:159]
    v_mfma_f32_16x16x32_bf16 v[164:167], v[216:219], v[116:119], v[164:167]
    v_mfma_f32_16x16x32_bf16 v[168:171], v[212:215], v[220:223], v[168:171]
    v_mfma_f32_16x16x32_bf16 v[176:179], v[216:219], v[220:223], v[176:179]
    v_mfma_f32_16x16x32_bf16 v[180:183], v[212:215], v[224:227], v[180:183]
    v_mfma_f32_16x16x32_bf16 v[188:191], v[216:219], v[224:227], v[188:191]
    v_mfma_f32_16x16x32_bf16 v[196:199], v[212:215], v[228:231], v[196:199]
    v_mfma_f32_16x16x32_bf16 v[204:207], v[216:219], v[228:231], v[204:207]
    s_nop 3
    ds_read_b128 v[212:215], v250 offset:8704
    ds_read_b128 v[216:219], v250 offset:10752
    ds_read_b128 v[220:223], v253 offset:512
    ds_read_b128 v[224:227], v253 offset:8704
    ds_read_b128 v[228:231], v253 offset:16896
    s_waitcnt lgkmcnt(0)
    v_mfma_f32_16x16x32_bf16 v[144:147], v[212:215], v[88:91], v[144:147]
    v_mfma_f32_16x16x32_bf16 v[152:155], v[216:219], v[88:91], v[152:155]
    v_mfma_f32_16x16x32_bf16 v[156:159], v[212:215], v[120:123], v[156:159]
    v_mfma_f32_16x16x32_bf16 v[164:167], v[216:219], v[120:123], v[164:167]
    v_mfma_f32_16x16x32_bf16 v[168:171], v[212:215], v[220:223], v[168:171]
    v_mfma_f32_16x16x32_bf16 v[176:179], v[216:219], v[220:223], v[176:179]
    v_mfma_f32_16x16x32_bf16 v[180:183], v[212:215], v[224:227], v[180:183]
    v_mfma_f32_16x16x32_bf16 v[188:191], v[216:219], v[224:227], v[188:191]
    v_mfma_f32_16x16x32_bf16 v[196:199], v[212:215], v[228:231], v[196:199]
    v_mfma_f32_16x16x32_bf16 v[204:207], v[216:219], v[228:231], v[204:207]
    s_nop 3
    ds_read_b128 v[212:215], v250 offset:8960
    ds_read_b128 v[216:219], v250 offset:11008
    ds_read_b128 v[220:223], v253 offset:768
    ds_read_b128 v[224:227], v253 offset:8960
    ds_read_b128 v[228:231], v253 offset:17152
    s_waitcnt lgkmcnt(0)
    v_mfma_f32_16x16x32_bf16 v[144:147], v[212:215], v[92:95], v[144:147]
    v_mfma_f32_16x16x32_bf16 v[152:155], v[216:219], v[92:95], v[152:155]
    v_mfma_f32_16x16x32_bf16 v[156:159], v[212:215], v[124:127], v[156:159]
    v_mfma_f32_16x16x32_bf16 v[164:167], v[216:219], v[124:127], v[164:167]
    v_mfma_f32_16x16x32_bf16 v[168:171], v[212:215], v[220:223], v[168:171]
    v_mfma_f32_16x16x32_bf16 v[176:179], v[216:219], v[220:223], v[176:179]
    v_mfma_f32_16x16x32_bf16 v[180:183], v[212:215], v[224:227], v[180:183]
    v_mfma_f32_16x16x32_bf16 v[188:191], v[216:219], v[224:227], v[188:191]
    v_mfma_f32_16x16x32_bf16 v[196:199], v[212:215], v[228:231], v[196:199]
    v_mfma_f32_16x16x32_bf16 v[204:207], v[216:219], v[228:231], v[204:207]
    s_nop 3
    v_max3_f32 v240, v240, v144, v145
    v_max3_f32 v240, v240, v146, v147
    v_max3_f32 v240, v240, v152, v153
    v_max3_f32 v240, v240, v154, v155
    v_max3_f32 v241, v241, v156, v157
    v_max3_f32 v241, v241, v158, v159
    v_max3_f32 v241, v241, v164, v165
    v_max3_f32 v241, v241, v166, v167
    v_max3_f32 v242, v242, v168, v169
    v_max3_f32 v242, v242, v170, v171
    v_max3_f32 v242, v242, v176, v177
    v_max3_f32 v242, v242, v178, v179
    v_max3_f32 v243, v243, v180, v181
    v_max3_f32 v243, v243, v182, v183
    v_max3_f32 v243, v243, v188, v189
    v_max3_f32 v243, v243, v190, v191
    v_max3_f32 v244, v244, v196, v197
    v_max3_f32 v244, v244, v198, v199
    v_max3_f32 v244, v244, v204, v205
    v_max3_f32 v244, v244, v206, v207
    s_sub_u32 s27, s27, 1
    s_cmp_lg_u32 s27, 0
    s_cbranch_scc1 L_fbloop
    v_mov_b32 v245, v240
    s_nop 1
    v_permlane32_swap_b32 v240, v245
    v_max_f32 v240, v240, v245
    v_mov_b32 v245, v240
    s_nop 1
    v_permlane16_swap_b32 v240, v245
    v_max_f32 v240, v240, v245
    v_mul_f32_e64 v240, -v240, s26
    v_mov_b32 v246, v241
    s_nop 1
    v_permlane32_swap_b32 v241, v246
    v_max_f32 v241, v241, v246
    v_mov_b32 v246, v241
    s_nop 1
    v_permlane16_swap_b32 v241, v246
    v_max_f32 v241, v241, v246
    v_mul_f32_e64 v241, -v241, s26
    v_mov_b32 v247, v242
    s_nop 1
    v_permlane32_swap_b32 v242, v247
    v_max_f32 v242, v242, v247
    v_mov_b32 v247, v242
    s_nop 1
    v_permlane16_swap_b32 v242, v247
    v_max_f32 v242, v242, v247
    v_mul_f32_e64 v242, -v242, s26
    v_mov_b32 v248, v243
    s_nop 1
    v_permlane32_swap_b32 v243, v248
    v_max_f32 v243, v243, v248
    v_mov_b32 v248, v243
    s_nop 1
    v_permlane16_swap_b32 v243, v248
    v_max_f32 v243, v243, v248
    v_mul_f32_e64 v243, -v243, s26
    v_mov_b32 v249, v244
    s_nop 1
    v_permlane32_swap_b32 v244, v249
    v_max_f32 v244, v244, v249
    v_mov_b32 v249, v244
    s_nop 1
    v_permlane16_swap_b32 v244, v249
    v_max_f32 v244, v244, v249
    v_mul_f32_e64 v244, -v244, s26
    s_nop 7
    s_barrier
    s_branch L_restart
L_end:
    s_endpgm
L_codeend:

.section .rodata,"a"
.p2align 6
.amdhsa_kernel standalone__mha_softmax__near_ridge_kernel
  .amdhsa_next_free_vgpr 512
  .amdhsa_next_free_sgpr 102
  .amdhsa_accum_offset 256
  .amdhsa_group_segment_fixed_size 0
  .amdhsa_kernarg_size 48
  .amdhsa_user_sgpr_count 2
  .amdhsa_user_sgpr_kernarg_segment_ptr 1
  .amdhsa_system_sgpr_workgroup_id_x 1
.end_amdhsa_kernel
```
